```python
import torch

def _softmax(x, axis=-1):
    return torch.softmax(x, dim=axis)
def _gelu(x):
    return torch.nn.functional.gelu(x, approximate="tanh")
def _silu(x):
    return torch.nn.functional.silu(x)
def _sigmoid(x):
    return torch.sigmoid(x)
def _layernorm(x, axis=-1, eps=1e-5):
    m = x.mean(dim=axis, keepdim=True)
    v = x.var(dim=axis, keepdim=True, unbiased=False)
    return (x - m) / torch.sqrt(v + eps)
def _scatter_add(tgt, idx, src, axis=0):
    return tgt.clone().index_add_(axis, idx, src)
def _segment_sum(src, seg, n):
    out = torch.zeros((n,) + src.shape[1:], dtype=src.dtype)
    return out.index_add_(0, seg, src)
def _pad(x, pw):
    flat = tuple(v for pair in reversed(pw) for v in pair)
    return torch.nn.functional.pad(x, flat)

kernel_name = 'sequential_preLN__grouped_kv_mqa__dense_activation_squared_relu__prompt'

def setup_inputs():

    _w = (lambda a: (lambda t: t.to(torch.bfloat16) if t.is_floating_point() else t)(torch.as_tensor(a)))
    def _A_setup():
        B, S, D, H = 1, 2048, 640, 32
        Dh = D // H
        return {
            "x": _w((lambda *s: torch.randn(*s, dtype=torch.bfloat16) * 0.05)(B, S, D)),
            "wq": _w((lambda *s: torch.randn(*s, dtype=torch.bfloat16) * 0.05)(D, H * Dh)),
            "wk": _w((lambda *s: torch.randn(*s, dtype=torch.bfloat16) * 0.05)(D, Dh)),
            "wv": _w((lambda *s: torch.randn(*s, dtype=torch.bfloat16) * 0.05)(D, Dh)),
            "wo": _w((lambda *s: torch.randn(*s, dtype=torch.bfloat16) * 0.05)(H * Dh, D)),
        }
    _A_in = _A_setup()

    def _B_setup():
        B, S, D, F = 1, 2048, 640, 1536
        return {
            "x": _w((lambda *s: torch.randn(*s, dtype=torch.bfloat16) * 0.05)(B, S, D)),
            "w1": _w((lambda *s: torch.randn(*s, dtype=torch.bfloat16) * 0.05)(D, F)),
            "b1": _w((lambda *s: torch.randn(*s, dtype=torch.bfloat16) * 0.8)(F)),
            "w2": _w((lambda *s: torch.randn(*s, dtype=torch.bfloat16) * 0.05)(F, D)),
            "b2": _w((lambda *s: torch.randn(*s, dtype=torch.bfloat16) * 3.2)(D)),
        }
    _B_in = _B_setup()

    return {
        "A_x": _A_in["x"],
        "A_wq": _A_in["wq"],
        "A_wk": _A_in["wk"],
        "A_wv": _A_in["wv"],
        "A_wo": _A_in["wo"],
        "B_x": _B_in["x"],
        "B_w1": _B_in["w1"],
        "B_b1": _B_in["b1"],
        "B_w2": _B_in["w2"],
        "B_b2": _B_in["b2"],
    }

def reference(A_x, A_wq, A_wk, A_wv, A_wo, B_x, B_w1, B_b1, B_w2, B_b2):
    def _A_ref(x, wq, wk, wv, wo):
        B, S, D = x.shape
        H = 32
        Dh = D // H
        q = (lambda x, *d: x.permute(*d))((x @ wq).reshape(B, S, H, Dh), 0, 2, 1, 3)
        k = x @ wk
        v = x @ wv
        scores = torch.einsum("bhqd,bkd->bhqk", q, k) * (Dh ** -0.5)
        p = _softmax(scores, axis=-1)
        o = torch.einsum("bhqk,bkd->bhqd", p, v)
        return (lambda x, *d: x.permute(*d))(o, 0, 2, 1, 3).reshape(B, S, H * Dh) @ wo

    def _B_ref(x, w1, b1, w2, b2):
        h = torch.einsum("bsd,df->bsf", x, w1) + b1
        zero = torch.zeros_like(h)
        r = torch.where(h > zero, h, zero)
        h = r * r
        out = torch.einsum("bsf,fd->bsd", h, w2) + b2
        return out

    x = A_x
    h = x + _A_ref(_layernorm(x, axis=-1), A_wq, A_wk, A_wv, A_wo)
    h2 = h + _B_ref(_layernorm(h, axis=-1), B_w1, B_b1, B_w2, B_b2)
    return h2
```

```asm
; @launch grid=(256,1,1) block=(512,1,1) lds=163840
.amdgcn_target "amdgcn-amd-amdhsa--gfx950"
.text
.globl sequential_preLN__grouped_kv_mqa__dense_activation_squared_relu__prompt_kernel
.p2align 8
.type sequential_preLN__grouped_kv_mqa__dense_activation_squared_relu__prompt_kernel,@function
sequential_preLN__grouped_kv_mqa__dense_activation_squared_relu__prompt_kernel:
    s_cmp_ge_u32 s2, 256
    s_cbranch_scc1 sequential_preLN__grouped_kv_mqa__dense_activation_squared_relu__prompt_kernel_end
    s_load_dwordx16 s[8:23], s[0:1], 0
    s_load_dwordx8 s[24:31], s[0:1], 64
    s_load_dwordx2 s[32:33], s[0:1], 96
    v_lshrrev_b32 v2, 6, v0
    v_and_b32 v1, 63, v0
    v_readfirstlane_b32 s3, v2
    s_and_b32 s6, s2, 7
    s_lshr_b32 s7, s2, 3
    s_and_b32 s5, s7, 7
    s_lshr_b32 s4, s7, 3
    s_lshl_b32 s60, s6, 2
    s_add_u32 s4, s4, s60
    s_and_b32 s61, s7, 15
    s_lshr_b32 s60, s7, 4
    s_lshl_b32 s6, s6, 1
    s_add_u32 s60, s60, s6
    s_lshr_b32 s6, s3, 1
    s_lshl_b32 s34, s5, 2
    s_add_u32 s34, s34, s6
    s_and_b32 s35, s3, 1
    v_and_b32 v11, 31, v1
    v_lshrrev_b32 v12, 5, v1
    s_mul_i32 s7, s3, 3072
    v_lshlrev_b32 v8, 4, v1
    v_add_u32 v4, s7, v8
    s_lshl_b32 s6, s4, 1
    s_add_u32 s6, s6, s35
    s_lshl_b32 s63, s6, 5
    v_mov_b32 v224, 163824
    v_mov_b32 v225, 0
    ds_write_b32 v224, v225
    v_mov_b32 v132, 0
    v_mov_b32 v133, 0
    v_mov_b32 v134, 0
    v_mov_b32 v135, 0
    v_mov_b32 v136, 0
    v_mov_b32 v137, 0
    v_mov_b32 v138, 0
    s_cmp_ge_u32 s3, 4
    s_cbranch_scc1 L_p0ld
    s_and_b32 s48, s5, 3
    s_lshl_b32 s6, s4, 2
    s_add_u32 s6, s6, s48
    s_lshl_b32 s49, s6, 4
    v_and_b32 v226, 15, v1
    v_add_u32 v228, s49, v226
    v_lshrrev_b32 v230, 4, v1
    v_mul_u32_u24 v226, 1280, v228
    v_lshl_add_u32 v226, v230, 4, v226
    s_mul_i32 s50, s3, 320
    s_mul_i32 s51, s3, 6400
    s_mul_i32 s52, s3, 7168
    s_add_u32 s52, s52, 0
    s_waitcnt lgkmcnt(0)
    s_barrier
    s_mov_b32 s40, s8
    s_mov_b32 s41, s9
    s_mov_b32 s42, 0x280000
    s_mov_b32 s43, 0x00020000
    s_cmp_ge_u32 s5, 4
    s_cselect_b32 s44, s14, s12
    s_cselect_b32 s45, s15, s13
    s_mov_b32 s46, 25600
    s_mov_b32 s47, 0x00020000
    s_mov_b32 m0, s52
    buffer_load_dwordx4 v[140:143], v226, s[40:43], s50 offen offset:0
    buffer_load_dwordx4 v[144:147], v226, s[40:43], s50 offen offset:64
    buffer_load_dwordx4 v[148:151], v226, s[40:43], s50 offen offset:128
    buffer_load_dwordx4 v[152:155], v226, s[40:43], s50 offen offset:192
    buffer_load_dwordx4 v[156:159], v226, s[40:43], s50 offen offset:256
    buffer_load_dwordx4 v8, s[44:47], s51 offen offset:0 lds
    buffer_load_dwordx4 v8, s[44:47], s51 offen offset:1024 lds
    buffer_load_dwordx4 v8, s[44:47], s51 offen offset:2048 lds
    buffer_load_dwordx4 v8, s[44:47], s51 offen offset:3072 lds
    s_add_u32 m0, m0, 0x1000
    s_add_u32 s51, s51, 0x1000
    buffer_load_dwordx4 v8, s[44:47], s51 offen offset:0 lds
    buffer_load_dwordx4 v8, s[44:47], s51 offen offset:1024 lds
    buffer_load_dwordx4 v8, s[44:47], s51 offen offset:2048 lds
    v_lshrrev_b32 v238, 3, v11
    s_lshl_b32 s6, s35, 2
    v_add_u32 v238, s6, v238
    v_lshlrev_b32 v238, 10, v238
    v_and_b32 v239, 7, v11
    v_lshl_add_u32 v238, v239, 7, v238
    v_bfe_u32 v239, v11, 1, 3
    v_xor_b32 v239, v239, v12
    s_lshl_b32 s6, s35, 1
    v_xor_b32 v239, s6, v239
    v_xor_b32 v240, 0, v239
    v_lshl_add_u32 v244, v240, 4, v238
    v_xor_b32 v240, 2, v239
    v_lshl_add_u32 v245, v240, 4, v238
    v_xor_b32 v240, 4, v239
    v_lshl_add_u32 v246, v240, 4, v238
    v_xor_b32 v240, 6, v239
    v_lshl_add_u32 v247, v240, 4, v238
    v_bfe_u32 v238, v1, 2, 2
    v_lshl_add_u32 v238, v12, 3, v238
    v_mul_u32_u24 v238, 160, v238
    v_bfe_u32 v239, v1, 4, 1
    v_lshl_add_u32 v238, v239, 5, v238
    v_and_b32 v239, 3, v1
    v_lshl_add_u32 v238, v239, 3, v238
    s_lshr_b32 s6, s3, 1
    s_mul_i32 s6, s6, 40
    s_add_u32 s6, s6, 16384
    s_mul_i32 s96, s35, 2560
    s_add_u32 s98, s6, s96
    v_add_u32 v248, s98, v238
    s_sub_u32 s98, s6, s96
    v_add_u32 v249, s98, v238
    v_add_u32 v244, 110592, v244
    v_add_u32 v245, 110592, v245
    v_add_u32 v246, 110592, v246
    v_add_u32 v247, 110592, v247
    v_add_u32 v248, 110592, v248
    v_add_u32 v249, 110592, v249
    v_lshlrev_b32 v9, 3, v11
    v_add_u32 v9, 1024, v9
    v_sub_u32 v15, 1, v12
    v_mul_lo_u32 v9, v9, v15
    v_mul_u32_u24 v16, 1600, v12
    v_add_u32 v9, v9, v16
    v_min_u32 v10, 21, v11
    v_mad_u32_u24 v10, v12, 22, v10
    v_lshlrev_b32 v10, 4, v10
    v_add_u32 v10, 1280, v10
    s_mul_i32 s97, s35, 11264
    s_add_u32 s6, s97, 135168
    v_add_u32 v5, 135168, v8
    v_add_u32 v6, 135168, v9
    v_add_u32 v7, s6, v10
    v_mov_b32 v100, 0
    v_mov_b32 v101, 0
    v_mov_b32 v102, 0
    v_mov_b32 v103, 0
    v_mov_b32 v104, 0
    v_mov_b32 v105, 0
    v_mov_b32 v106, 0
    v_mov_b32 v107, 0
    v_mov_b32 v108, 0
    v_mov_b32 v109, 0
    v_mov_b32 v110, 0
    v_mov_b32 v111, 0
    v_mov_b32 v112, 0
    v_mov_b32 v113, 0
    v_mov_b32 v114, 0
    v_mov_b32 v115, 0
    v_mov_b32 v116, 0
    v_mov_b32 v117, 0
    v_mov_b32 v118, 0
    v_mov_b32 v119, 0
    v_mov_b32 v120, 0
    v_mov_b32 v121, 0
    v_mov_b32 v122, 0
    v_mov_b32 v123, 0
    v_mov_b32 v124, 0
    v_mov_b32 v125, 0
    v_mov_b32 v126, 0
    v_mov_b32 v127, 0
    v_mov_b32 v128, 0
    v_mov_b32 v129, 0
    v_mov_b32 v130, 0
    v_mov_b32 v131, 0
    v_mov_b32 v252, 0
    v_mov_b32 v253, 0
    v_mov_b32 v254, 0
    s_mov_b32 s54, 0
    s_mov_b32 s55, 0
    s_mov_b32 s96, 0
    s_mov_b32 s98, 0
    s_mov_b32 s99, 0
    s_mov_b32 s100, 0
    s_mov_b32 s101, 0
    v_bfe_u32 v227, v1, 2, 2
    v_lshl_add_u32 v227, v230, 3, v227
    v_mul_u32_u24 v227, 40, v227
    v_and_b32 v229, 3, v1
    v_lshl_add_u32 v227, v229, 3, v227
    v_add_u32 v227, s52, v227
    v_mov_b32 v60, 0x3f803f80
    v_mov_b32 v61, 0x3f803f80
    v_mov_b32 v62, 0x3f803f80
    v_mov_b32 v63, 0x3f803f80
    s_add_u32 s36, s32, 0x280000
    s_addc_u32 s37, s33, 0
    s_mov_b32 s38, 0x2c000
    s_mov_b32 s39, 0x00020000
    s_add_u32 s64, s32, 0x2000000
    s_addc_u32 s65, s33, 0
    s_mov_b32 s66, 0x100000
    s_mov_b32 s67, 0x00020000
    s_mov_b32 s56, s30
    s_mov_b32 s57, s31
    s_mov_b32 s58, 0x100
    s_mov_b32 s59, 0x00020000
    s_waitcnt vmcnt(0)
    ds_read_b64_tr_b16 v[160:161], v227 offset:0
    ds_read_b64_tr_b16 v[162:163], v227 offset:160
    ds_read_b64_tr_b16 v[164:165], v227 offset:32
    ds_read_b64_tr_b16 v[166:167], v227 offset:192
    ds_read_b64_tr_b16 v[168:169], v227 offset:1280
    ds_read_b64_tr_b16 v[170:171], v227 offset:1440
    ds_read_b64_tr_b16 v[172:173], v227 offset:1312
    ds_read_b64_tr_b16 v[174:175], v227 offset:1472
    ds_read_b64_tr_b16 v[176:177], v227 offset:2560
    ds_read_b64_tr_b16 v[178:179], v227 offset:2720
    ds_read_b64_tr_b16 v[180:181], v227 offset:2592
    ds_read_b64_tr_b16 v[182:183], v227 offset:2752
    s_waitcnt lgkmcnt(4)
    ds_read_b64_tr_b16 v[184:185], v227 offset:3840
    ds_read_b64_tr_b16 v[186:187], v227 offset:4000
    ds_read_b64_tr_b16 v[188:189], v227 offset:3872
    ds_read_b64_tr_b16 v[190:191], v227 offset:4032
    ds_read_b64_tr_b16 v[192:193], v227 offset:5120
    ds_read_b64_tr_b16 v[194:195], v227 offset:5280
    ds_read_b64_tr_b16 v[196:197], v227 offset:5152
    ds_read_b64_tr_b16 v[198:199], v227 offset:5312
    v_mfma_f32_16x16x32_bf16 v[216:219], v[60:63], v[140:143], 0
    v_mfma_f32_16x16x32_bf16 v[220:223], v[140:143], v[140:143], 0
    s_waitcnt lgkmcnt(0)
    v_mfma_f32_16x16x32_bf16 v[200:203], v[160:163], v[140:143], 0
    v_mfma_f32_16x16x32_bf16 v[208:211], v[160:163], v[60:63], 0
    v_mfma_f32_16x16x32_bf16 v[204:207], v[164:167], v[140:143], 0
    v_mfma_f32_16x16x32_bf16 v[212:215], v[164:167], v[60:63], 0
    v_mfma_f32_16x16x32_bf16 v[216:219], v[60:63], v[144:147], v[216:219]
    v_mfma_f32_16x16x32_bf16 v[220:223], v[144:147], v[144:147], v[220:223]
    v_mfma_f32_16x16x32_bf16 v[200:203], v[168:171], v[144:147], v[200:203]
    v_mfma_f32_16x16x32_bf16 v[208:211], v[168:171], v[60:63], v[208:211]
    v_mfma_f32_16x16x32_bf16 v[204:207], v[172:175], v[144:147], v[204:207]
    v_mfma_f32_16x16x32_bf16 v[212:215], v[172:175], v[60:63], v[212:215]
    v_mfma_f32_16x16x32_bf16 v[216:219], v[60:63], v[148:151], v[216:219]
    v_mfma_f32_16x16x32_bf16 v[220:223], v[148:151], v[148:151], v[220:223]
    v_mfma_f32_16x16x32_bf16 v[200:203], v[176:179], v[148:151], v[200:203]
    v_mfma_f32_16x16x32_bf16 v[208:211], v[176:179], v[60:63], v[208:211]
    v_mfma_f32_16x16x32_bf16 v[204:207], v[180:183], v[148:151], v[204:207]
    v_mfma_f32_16x16x32_bf16 v[212:215], v[180:183], v[60:63], v[212:215]
    v_mfma_f32_16x16x32_bf16 v[216:219], v[60:63], v[152:155], v[216:219]
    v_mfma_f32_16x16x32_bf16 v[220:223], v[152:155], v[152:155], v[220:223]
    v_mfma_f32_16x16x32_bf16 v[200:203], v[184:187], v[152:155], v[200:203]
    v_mfma_f32_16x16x32_bf16 v[208:211], v[184:187], v[60:63], v[208:211]
    v_mfma_f32_16x16x32_bf16 v[204:207], v[188:191], v[152:155], v[204:207]
    v_mfma_f32_16x16x32_bf16 v[212:215], v[188:191], v[60:63], v[212:215]
    v_mfma_f32_16x16x32_bf16 v[216:219], v[60:63], v[156:159], v[216:219]
    v_mfma_f32_16x16x32_bf16 v[220:223], v[156:159], v[156:159], v[220:223]
    v_mfma_f32_16x16x32_bf16 v[200:203], v[192:195], v[156:159], v[200:203]
    v_mfma_f32_16x16x32_bf16 v[208:211], v[192:195], v[60:63], v[208:211]
    v_mfma_f32_16x16x32_bf16 v[204:207], v[196:199], v[156:159], v[204:207]
    v_mfma_f32_16x16x32_bf16 v[212:215], v[196:199], v[60:63], v[212:215]
    v_and_b32 v226, 15, v1
    v_lshlrev_b32 v227, 2, v230
    v_sub_u32 v226, v226, v227
    s_nop 7
    v_mov_b32 v217, 0
    v_cmp_eq_u32 vcc, 0, v226
    s_nop 1
    v_cndmask_b32 v217, v217, v220, vcc
    v_cmp_eq_u32 vcc, 1, v226
    s_nop 1
    v_cndmask_b32 v217, v217, v221, vcc
    v_cmp_eq_u32 vcc, 2, v226
    s_nop 1
    v_cndmask_b32 v217, v217, v222, vcc
    v_cmp_eq_u32 vcc, 3, v226
    s_nop 1
    v_cndmask_b32 v217, v217, v223, vcc
    s_cmp_eq_u32 s3, 0
    s_cbranch_scc1 L_p0fin
    s_mul_i32 s6, s3, 3072
    s_add_u32 s6, s6, 148480
    v_add_u32 v226, s6, v8
    v_lshl_add_u32 v227, v230, 4, s6
    ds_write_b128 v226, v[200:203]
    ds_write_b128 v226, v[204:207] offset:1024
    v_lshrrev_b32 v229, 1, v8
    v_add_u32 v229, s6, v229
    ds_write_b64 v229, v[216:217] offset:2048
    ds_write_b128 v227, v[208:211] offset:2560
    ds_write_b128 v227, v[212:215] offset:2624
    v_mov_b32 v225, 1
    s_waitcnt lgkmcnt(0)
    s_mov_b64 exec, 1
    ds_add_u32 v224, v225
    s_mov_b64 exec, -1
    s_cmp_lg_u32 s3, 3
    s_cbranch_scc1 L_p0q
    v_mov_b32 v232, 0
    buffer_load_dwordx2 v[234:235], v232, s[56:59], 0 offen sc1
    s_branch L_p0q
L_p0fin:
    v_mov_b32 v232, 0
    buffer_load_dwordx2 v[234:235], v232, s[56:59], 0 offen sc1
    s_mov_b32 s53, 262144
L_p0sp:
    ds_read_b32 v225, v224
    s_sub_u32 s53, s53, 1
    s_waitcnt lgkmcnt(0)
    v_readfirstlane_b32 s6, v225
    s_cmp_eq_u32 s53, 0
    s_cselect_b32 s6, 3, s6
    s_cmp_lt_u32 s6, 3
    s_cbranch_scc1 L_p0sp
    v_add_u32 v226, 151552, v8
    v_lshlrev_b32 v227, 4, v230
    v_add_u32 v227, 151552, v227
    v_lshrrev_b32 v229, 1, v8
    v_add_u32 v229, 151552, v229
    ds_read_b128 v[140:143], v226 offset:0
    ds_read_b128 v[144:147], v226 offset:1024
    ds_read_b128 v[148:151], v227 offset:2560
    ds_read_b128 v[152:155], v227 offset:2624
    ds_read_b64 v[156:157], v229 offset:2048
    ds_read_b128 v[160:163], v226 offset:3072
    ds_read_b128 v[164:167], v226 offset:4096
    ds_read_b128 v[168:171], v227 offset:5632
    ds_read_b128 v[172:175], v227 offset:5696
    ds_read_b64 v[176:177], v229 offset:5120
    ds_read_b128 v[180:183], v226 offset:6144
    ds_read_b128 v[184:187], v226 offset:7168
    ds_read_b128 v[188:191], v227 offset:8704
    ds_read_b128 v[192:195], v227 offset:8768
    ds_read_b64 v[196:197], v229 offset:8192
    s_waitcnt lgkmcnt(10)
    v_pk_add_f32 v[200:201], v[200:201], v[140:141]
    v_pk_add_f32 v[202:203], v[202:203], v[142:143]
    v_pk_add_f32 v[204:205], v[204:205], v[144:145]
    v_pk_add_f32 v[206:207], v[206:207], v[146:147]
    v_pk_add_f32 v[208:209], v[208:209], v[148:149]
    v_pk_add_f32 v[210:211], v[210:211], v[150:151]
    v_pk_add_f32 v[212:213], v[212:213], v[152:153]
    v_pk_add_f32 v[214:215], v[214:215], v[154:155]
    v_pk_add_f32 v[216:217], v[216:217], v[156:157]
    s_waitcnt lgkmcnt(5)
    v_pk_add_f32 v[200:201], v[200:201], v[160:161]
    v_pk_add_f32 v[202:203], v[202:203], v[162:163]
    v_pk_add_f32 v[204:205], v[204:205], v[164:165]
    v_pk_add_f32 v[206:207], v[206:207], v[166:167]
    v_pk_add_f32 v[208:209], v[208:209], v[168:169]
    v_pk_add_f32 v[210:211], v[210:211], v[170:171]
    v_pk_add_f32 v[212:213], v[212:213], v[172:173]
    v_pk_add_f32 v[214:215], v[214:215], v[174:175]
    v_pk_add_f32 v[216:217], v[216:217], v[176:177]
    s_waitcnt lgkmcnt(0)
    v_pk_add_f32 v[200:201], v[200:201], v[180:181]
    v_pk_add_f32 v[202:203], v[202:203], v[182:183]
    v_pk_add_f32 v[204:205], v[204:205], v[184:185]
    v_pk_add_f32 v[206:207], v[206:207], v[186:187]
    v_pk_add_f32 v[208:209], v[208:209], v[188:189]
    v_pk_add_f32 v[210:211], v[210:211], v[190:191]
    v_pk_add_f32 v[212:213], v[212:213], v[192:193]
    v_pk_add_f32 v[214:215], v[214:215], v[194:195]
    v_pk_add_f32 v[216:217], v[216:217], v[196:197]
    v_mov_b32 v226, v217
    s_nop 1
    v_permlane16_swap_b32 v217, v226
    s_nop 1
    v_add_f32 v217, v217, v226
    v_mov_b32 v226, v217
    s_nop 1
    v_permlane32_swap_b32 v217, v226
    s_nop 1
    v_add_f32 v217, v217, v226
    v_mul_f32 v236, 0x3acccccd, v216
    v_mul_f32 v226, 0x3acccccd, v217
    v_fma_f32 v226, -v236, v236, v226
    v_max_f32 v226, 0, v226
    v_cvt_pk_bf16_f32 v226, v226, v226
    v_lshlrev_b32 v226, 16, v226
    v_add_f32 v226, 0x3727c5ac, v226
    v_cvt_pk_bf16_f32 v226, v226, v226
    v_lshlrev_b32 v226, 16, v226
    v_sqrt_f32 v226, v226
    s_nop 0
    v_cvt_pk_bf16_f32 v226, v226, v226
    v_lshlrev_b32 v226, 16, v226
    v_rcp_f32 v237, v226
    v_cvt_pk_bf16_f32 v236, v236, v236
    v_lshlrev_b32 v236, 16, v236
    v_fma_f32 v200, -v236, v208, v200
    v_mul_f32 v200, v200, v237
    v_fma_f32 v201, -v236, v209, v201
    v_mul_f32 v201, v201, v237
    v_fma_f32 v202, -v236, v210, v202
    v_mul_f32 v202, v202, v237
    v_fma_f32 v203, -v236, v211, v203
    v_mul_f32 v203, v203, v237
    v_fma_f32 v204, -v236, v212, v204
    v_mul_f32 v204, v204, v237
    v_fma_f32 v205, -v236, v213, v205
    v_mul_f32 v205, v205, v237
    v_fma_f32 v206, -v236, v214, v206
    v_mul_f32 v206, v206, v237
    v_fma_f32 v207, -v236, v215, v207
    v_mul_f32 v207, v207, v237
    v_cvt_pk_bf16_f32 v208, v200, v201
    v_cvt_pk_bf16_f32 v209, v202, v203
    v_cvt_pk_bf16_f32 v210, v204, v205
    v_cvt_pk_bf16_f32 v211, v206, v207
    v_lshrrev_b32 v229, 5, v228
    v_mul_u32_u24 v229, 2816, v229
    v_and_b32 v231, 31, v228
    s_cmp_ge_u32 s5, 4
    s_cbranch_scc1 L_p0v
    v_lshl_add_u32 v232, v231, 4, v229
    v_and_b32 v233, 1, v230
    v_lshl_add_u32 v232, v233, 9, v232
    v_lshrrev_b32 v233, 1, v230
    v_lshl_add_u32 v232, v233, 3, v232
    buffer_store_dwordx2 v[208:209], v232, s[36:39], 0 offen sc1
    v_lshl_add_u32 v229, v231, 3, v229
    v_mul_f32 v237, 0x3ea52b5c, v237
    v_lshlrev_b32 v233, 3, v228
    s_mov_b32 s44, s32
    s_mov_b32 s45, s33
    s_mov_b32 s46, 0x4000
    s_mov_b32 s47, 0x00020000
    s_mov_b32 exec_lo, 0xffff
    s_mov_b32 exec_hi, 0x0
    buffer_store_dwordx2 v[210:211], v229, s[36:39], 0 offen offset:1024 sc1
    buffer_store_dwordx2 v[236:237], v233, s[44:47], 0 offen sc1
    s_mov_b64 exec, -1
    s_branch L_p0q
L_p0v:
    v_bfe_u32 v232, v231, 2, 1
    v_mul_u32_u24 v232, 352, v232
    v_bfe_u32 v233, v231, 3, 1
    v_and_b32 v226, 3, v231
    v_lshl_add_u32 v233, v233, 2, v226
    v_lshl_add_u32 v232, v233, 1, v232
    v_lshl_add_u32 v232, v230, 6, v232
    v_add_u32 v232, 151552, v232
    s_mov_b32 exec_lo, 0xffff0000
    s_mov_b32 exec_hi, 0x0
    v_mov_b32 v210, 0x3f80
    s_mov_b64 exec, -1
    ds_write_b16 v232, v208
    ds_write_b16_d16_hi v232, v208 offset:16
    ds_write_b16 v232, v209 offset:32
    ds_write_b16_d16_hi v232, v209 offset:48
    s_mov_b32 exec_lo, 0xffffffff
    s_mov_b32 exec_hi, 0x0
    ds_write_b16 v232, v210 offset:256
    ds_write_b16_d16_hi v232, v210 offset:272
    s_mov_b32 exec_lo, 0xffff
    s_mov_b32 exec_hi, 0x0
    ds_write_b16 v232, v211 offset:288
    ds_write_b16_d16_hi v232, v211 offset:304
    s_mov_b64 exec, -1
    v_add_u32 v226, 151552, v8
    s_lshr_b32 s6, s49, 5
    s_mul_i32 s6, s6, 2816
    s_bfe_u32 s52, s49, 0x10004
    s_mul_i32 s52, s52, 768
    s_add_u32 s6, s6, s52
    s_waitcnt lgkmcnt(0)
    ds_read_b128 v[200:203], v226
    s_waitcnt lgkmcnt(0)
    s_mov_b32 exec_lo, 0xffffffff
    s_mov_b32 exec_hi, 0xffff
    buffer_store_dwordx4 v[200:203], v8, s[36:39], s6 offen offset:1280 sc1
    s_mov_b64 exec, -1
    s_branch L_p0q
L_p0ld:
    s_sub_u32 s48, s3, 4
    v_lshrrev_b32 v226, 3, v1
    s_lshl_b32 s6, s4, 6
    s_lshl_b32 s49, s48, 4
    s_add_u32 s6, s6, s49
    v_add_u32 v226, s6, v226
    v_mul_u32_u24 v226, 1280, v226
    v_and_b32 v227, 7, v1
    v_lshrrev_b32 v228, 4, v1
    v_xor_b32 v227, v227, v228
    v_lshl_add_u32 v132, v227, 4, v226
    v_xor_b32 v227, 4, v227
    v_lshl_add_u32 v133, v227, 4, v226
    v_add_u32 v133, 10240, v133
    s_and_b32 s49, s4, 3
    s_lshl_b32 s49, s49, 1
    s_add_u32 s49, s49, s5
    s_and_b32 s6, s2, 7
    s_add_u32 s49, s49, s6
    s_mul_i32 s6, s49, 13
    s_lshr_b32 s6, s6, 6
    s_mul_i32 s6, s6, 5
    s_sub_u32 s49, s49, s6
    s_lshl_b32 s49, s49, 8
    s_lshl_b32 s50, s48, 11
    s_mul_i32 s51, s48, 5120
    s_add_u32 s51, s51, 16384
    s_waitcnt lgkmcnt(0)
    s_barrier
    s_mov_b32 s40, s8
    s_mov_b32 s41, s9
    s_mov_b32 s42, 0x280000
    s_mov_b32 s43, 0x00020000
    s_mov_b32 s44, s10
    s_mov_b32 s45, s11
    s_mov_b32 s46, 0xc8000
    s_mov_b32 s47, 0x00020000
    s_mov_b32 s56, s30
    s_mov_b32 s57, s31
    s_mov_b32 s58, 0x100
    s_mov_b32 s59, 0x00020000
    s_lshl_b32 s6, s2, 3
    s_add_u32 s6, s6, s3
    s_cmp_lg_u32 s6, 7
    s_cbranch_scc1 L_p0nn
    s_memrealtime s[52:53]
    v_mov_b32 v226, 0
    s_waitcnt lgkmcnt(0)
    s_or_b32 s52, s52, 1
    v_mov_b32 v228, s52
    v_mov_b32 v229, s53
    s_mov_b64 exec, 1
    buffer_store_dwordx2 v[228:229], v226, s[56:59], 0 offen sc1
    s_mov_b64 exec, -1
L_p0nn:
    s_add_u32 m0, s50, 110592
    s_add_u32 s6, s49, 0
    buffer_load_dwordx4 v132, s[40:43], s6 offen lds
    s_add_u32 m0, s50, 111616
    s_add_u32 s6, s49, 0
    buffer_load_dwordx4 v133, s[40:43], s6 offen lds
    s_add_u32 m0, s50, 118784
    s_add_u32 s6, s49, 128
    buffer_load_dwordx4 v132, s[40:43], s6 offen lds
    s_add_u32 m0, s50, 119808
    s_add_u32 s6, s49, 128
    buffer_load_dwordx4 v133, s[40:43], s6 offen lds
    s_mul_i32 s6, s5, 160
    s_mul_i32 s52, s48, 40960
    s_add_u32 s6, s6, s52
    v_add_u32 v226, 0, v1
    v_mul_u32_u24 v227, 205, v226
    v_lshrrev_b32 v227, 11, v227
    v_mul_u32_u24 v228, 10, v227
    v_sub_u32 v226, v226, v228
    v_mul_u32_u24 v227, 1280, v227
    v_lshl_add_u32 v227, v226, 4, v227
    v_add_u32 v134, s6, v227
    v_add_u32 v226, 64, v1
    v_mul_u32_u24 v227, 205, v226
    v_lshrrev_b32 v227, 11, v227
    v_mul_u32_u24 v228, 10, v227
    v_sub_u32 v226, v226, v228
    v_mul_u32_u24 v227, 1280, v227
    v_lshl_add_u32 v227, v226, 4, v227
    v_add_u32 v135, s6, v227
    v_add_u32 v226, 128, v1
    v_mul_u32_u24 v227, 205, v226
    v_lshrrev_b32 v227, 11, v227
    v_mul_u32_u24 v228, 10, v227
    v_sub_u32 v226, v226, v228
    v_mul_u32_u24 v227, 1280, v227
    v_lshl_add_u32 v227, v226, 4, v227
    v_add_u32 v136, s6, v227
    v_add_u32 v226, 192, v1
    v_mul_u32_u24 v227, 205, v226
    v_lshrrev_b32 v227, 11, v227
    v_mul_u32_u24 v228, 10, v227
    v_sub_u32 v226, v226, v228
    v_mul_u32_u24 v227, 1280, v227
    v_lshl_add_u32 v227, v226, 4, v227
    v_add_u32 v137, s6, v227
    v_add_u32 v226, 256, v1
    v_mul_u32_u24 v227, 205, v226
    v_lshrrev_b32 v227, 11, v227
    v_mul_u32_u24 v228, 10, v227
    v_sub_u32 v226, v226, v228
    v_mul_u32_u24 v227, 1280, v227
    v_lshl_add_u32 v227, v226, 4, v227
    v_add_u32 v138, s6, v227
    s_add_u32 m0, s51, 110592
    s_mul_i32 s6, s49, 640
    buffer_load_dwordx4 v134, s[44:47], s6 offen lds
    s_add_u32 m0, s51, 111616
    s_mul_i32 s6, s49, 640
    buffer_load_dwordx4 v135, s[44:47], s6 offen lds
    s_add_u32 m0, s51, 112640
    s_mul_i32 s6, s49, 640
    buffer_load_dwordx4 v136, s[44:47], s6 offen lds
    s_add_u32 m0, s51, 113664
    s_mul_i32 s6, s49, 640
    buffer_load_dwordx4 v137, s[44:47], s6 offen lds
    s_add_u32 m0, s51, 114688
    s_mul_i32 s6, s49, 640
    buffer_load_dwordx4 v138, s[44:47], s6 offen lds
    s_add_u32 s49, s49, 256
    s_cmp_eq_u32 s49, 1280
    s_cselect_b32 s49, 0, s49
    v_lshlrev_b32 v226, 7, v1
    s_cmp_eq_u32 s3, 4
    s_cbranch_scc1 L_p0t4
    s_branch L_p0tx
    s_cmp_eq_u32 s3, 5
    s_cbranch_scc1 L_p0t5
    s_lshr_b32 s6, s2, 3
    s_mul_i32 s6, s6, 25600
    s_sub_u32 s52, s3, 6
    s_mul_i32 s52, s52, 12800
    s_add_u32 s6, s6, s52
    buffer_load_dword v255, v226, s[44:47], s6 offen
    s_add_u32 s6, s6, 4608
    buffer_load_dword v255, v226, s[44:47], s6 offen
    s_branch L_p0tx
L_p0t5:
    s_lshl_b32 s6, s4, 3
    s_add_u32 s6, s6, s5
    s_mul_i32 s6, s6, 10240
    buffer_load_dword v255, v226, s[40:43], s6 offen
    s_add_u32 s6, s6, 2048
    buffer_load_dword v255, v226, s[40:43], s6 offen
    s_branch L_p0tx
L_p0t4:
    s_getpc_b64 s[68:69]
L_cpf0:
    s_sub_u32 s68, s68, L_cpf0-sequential_preLN__grouped_kv_mqa__dense_activation_squared_relu__prompt_kernel
    s_subb_u32 s69, s69, 0
    s_mov_b32 s70, L_codeend-sequential_preLN__grouped_kv_mqa__dense_activation_squared_relu__prompt_kernel
    s_mov_b32 s71, 0x00020000
    s_mov_b32 s6, 0
    buffer_load_dword v255, v226, s[68:71], s6 offen
    s_mov_b32 s6, 8192
    buffer_load_dword v255, v226, s[68:71], s6 offen
    s_mov_b32 s6, 16384
    buffer_load_dword v255, v226, s[68:71], s6 offen
    s_mov_b32 s6, 24576
    buffer_load_dword v255, v226, s[68:71], s6 offen
    s_mov_b32 s6, 32768
    buffer_load_dword v255, v226, s[68:71], s6 offen
L_p0tx:
    s_add_u32 m0, s50, 73728
    s_add_u32 s6, s49, 0
    buffer_load_dwordx4 v132, s[40:43], s6 offen lds
    s_add_u32 m0, s50, 74752
    s_add_u32 s6, s49, 0
    buffer_load_dwordx4 v133, s[40:43], s6 offen lds
    s_add_u32 m0, s50, 81920
    s_add_u32 s6, s49, 128
    buffer_load_dwordx4 v132, s[40:43], s6 offen lds
    s_add_u32 m0, s50, 82944
    s_add_u32 s6, s49, 128
    buffer_load_dwordx4 v133, s[40:43], s6 offen lds
    s_add_u32 m0, s51, 73728
    s_mul_i32 s6, s49, 640
    buffer_load_dwordx4 v134, s[44:47], s6 offen lds
    s_add_u32 m0, s51, 74752
    s_mul_i32 s6, s49, 640
    buffer_load_dwordx4 v135, s[44:47], s6 offen lds
    s_add_u32 m0, s51, 75776
    s_mul_i32 s6, s49, 640
    buffer_load_dwordx4 v136, s[44:47], s6 offen lds
    s_add_u32 m0, s51, 76800
    s_mul_i32 s6, s49, 640
    buffer_load_dwordx4 v137, s[44:47], s6 offen lds
    s_add_u32 m0, s51, 77824
    s_mul_i32 s6, s49, 640
    buffer_load_dwordx4 v138, s[44:47], s6 offen lds
    s_add_u32 s49, s49, 256
    s_cmp_eq_u32 s49, 1280
    s_cselect_b32 s49, 0, s49
    v_lshrrev_b32 v238, 3, v11
    s_lshl_b32 s6, s35, 2
    v_add_u32 v238, s6, v238
    v_lshlrev_b32 v238, 10, v238
    v_and_b32 v239, 7, v11
    v_lshl_add_u32 v238, v239, 7, v238
    v_bfe_u32 v239, v11, 1, 3
    v_xor_b32 v239, v239, v12
    s_lshl_b32 s6, s35, 1
    v_xor_b32 v239, s6, v239
    v_xor_b32 v240, 0, v239
    v_lshl_add_u32 v244, v240, 4, v238
    v_xor_b32 v240, 2, v239
    v_lshl_add_u32 v245, v240, 4, v238
    v_xor_b32 v240, 4, v239
    v_lshl_add_u32 v246, v240, 4, v238
    v_xor_b32 v240, 6, v239
    v_lshl_add_u32 v247, v240, 4, v238
    v_bfe_u32 v238, v1, 2, 2
    v_lshl_add_u32 v238, v12, 3, v238
    v_mul_u32_u24 v238, 160, v238
    v_bfe_u32 v239, v1, 4, 1
    v_lshl_add_u32 v238, v239, 5, v238
    v_and_b32 v239, 3, v1
    v_lshl_add_u32 v238, v239, 3, v238
    s_lshr_b32 s6, s3, 1
    s_mul_i32 s6, s6, 40
    s_add_u32 s6, s6, 16384
    s_mul_i32 s96, s35, 2560
    s_add_u32 s98, s6, s96
    v_add_u32 v248, s98, v238
    s_sub_u32 s98, s6, s96
    v_add_u32 v249, s98, v238
    v_add_u32 v244, 110592, v244
    v_add_u32 v245, 110592, v245
    v_add_u32 v246, 110592, v246
    v_add_u32 v247, 110592, v247
    v_add_u32 v248, 110592, v248
    v_add_u32 v249, 110592, v249
    v_lshlrev_b32 v9, 3, v11
    v_add_u32 v9, 1024, v9
    v_sub_u32 v15, 1, v12
    v_mul_lo_u32 v9, v9, v15
    v_mul_u32_u24 v16, 1600, v12
    v_add_u32 v9, v9, v16
    v_min_u32 v10, 21, v11
    v_mad_u32_u24 v10, v12, 22, v10
    v_lshlrev_b32 v10, 4, v10
    v_add_u32 v10, 1280, v10
    s_mul_i32 s97, s35, 11264
    s_add_u32 s6, s97, 135168
    v_add_u32 v5, 135168, v8
    v_add_u32 v6, 135168, v9
    v_add_u32 v7, s6, v10
    v_mov_b32 v100, 0
    v_mov_b32 v101, 0
    v_mov_b32 v102, 0
    v_mov_b32 v103, 0
    v_mov_b32 v104, 0
    v_mov_b32 v105, 0
    v_mov_b32 v106, 0
    v_mov_b32 v107, 0
    v_mov_b32 v108, 0
    v_mov_b32 v109, 0
    v_mov_b32 v110, 0
    v_mov_b32 v111, 0
    v_mov_b32 v112, 0
    v_mov_b32 v113, 0
    v_mov_b32 v114, 0
    v_mov_b32 v115, 0
    v_mov_b32 v116, 0
    v_mov_b32 v117, 0
    v_mov_b32 v118, 0
    v_mov_b32 v119, 0
    v_mov_b32 v120, 0
    v_mov_b32 v121, 0
    v_mov_b32 v122, 0
    v_mov_b32 v123, 0
    v_mov_b32 v124, 0
    v_mov_b32 v125, 0
    v_mov_b32 v126, 0
    v_mov_b32 v127, 0
    v_mov_b32 v128, 0
    v_mov_b32 v129, 0
    v_mov_b32 v130, 0
    v_mov_b32 v131, 0
    v_mov_b32 v252, 0
    v_mov_b32 v253, 0
    v_mov_b32 v254, 0
    s_mov_b32 s54, 0
    s_mov_b32 s55, 0
    s_mov_b32 s96, 0
    s_mov_b32 s98, 0
    s_mov_b32 s99, 0
    s_mov_b32 s100, 0
    s_mov_b32 s101, 0
    v_mov_b32 v60, 0x3f803f80
    v_mov_b32 v61, 0x3f803f80
    v_mov_b32 v62, 0x3f803f80
    v_mov_b32 v63, 0x3f803f80
    s_add_u32 s36, s32, 0x280000
    s_addc_u32 s37, s33, 0
    s_mov_b32 s38, 0x2c000
    s_mov_b32 s39, 0x00020000
    s_add_u32 s64, s32, 0x2000000
    s_addc_u32 s65, s33, 0
    s_mov_b32 s66, 0x100000
    s_mov_b32 s67, 0x00020000
L_p0q:
    s_cmp_ge_u32 s3, 4
    s_cbranch_scc1 L_p0ql
    s_barrier
    ds_read_b128 v[44:47], v244 offset:0
    ds_read_b64_tr_b16 v[32:33], v248 offset:0
    ds_read_b64_tr_b16 v[34:35], v248 offset:640
    ds_read_b128 v[48:51], v245 offset:0
    ds_read_b64_tr_b16 v[36:37], v249 offset:2560
    ds_read_b64_tr_b16 v[38:39], v249 offset:3200
    ds_read_b128 v[52:55], v246 offset:0
    ds_read_b64_tr_b16 v[40:41], v248 offset:5120
    ds_read_b64_tr_b16 v[42:43], v248 offset:5760
    s_waitcnt lgkmcnt(6)
    v_mfma_f32_32x32x16_bf16 v[68:83], v[32:35], v[44:47], 0
    v_mfma_f32_32x32x16_bf16 v[84:99], v[32:35], v[60:63], 0
    ds_read_b128 v[44:47], v247 offset:0
    ds_read_b64_tr_b16 v[32:33], v249 offset:7680
    ds_read_b64_tr_b16 v[34:35], v249 offset:8320
    s_waitcnt lgkmcnt(6)
    v_mfma_f32_32x32x16_bf16 v[68:83], v[36:39], v[48:51], v[68:83]
    ds_read_b128 v[48:51], v244 offset:8192
    ds_read_b64_tr_b16 v[36:37], v248 offset:10240
    ds_read_b64_tr_b16 v[38:39], v248 offset:10880
    s_waitcnt lgkmcnt(6)
    v_mfma_f32_32x32x16_bf16 v[68:83], v[40:43], v[52:55], v[68:83]
    v_mfma_f32_32x32x16_bf16 v[84:99], v[40:43], v[60:63], v[84:99]
    ds_read_b128 v[52:55], v245 offset:8192
    ds_read_b64_tr_b16 v[40:41], v249 offset:12800
    ds_read_b64_tr_b16 v[42:43], v249 offset:13440
    s_waitcnt lgkmcnt(6)
    v_mfma_f32_32x32x16_bf16 v[68:83], v[32:35], v[44:47], v[68:83]
    ds_read_b128 v[44:47], v246 offset:8192
    ds_read_b64_tr_b16 v[32:33], v248 offset:15360
    ds_read_b64_tr_b16 v[34:35], v248 offset:16000
    s_waitcnt lgkmcnt(6)
    v_mfma_f32_32x32x16_bf16 v[68:83], v[36:39], v[48:51], v[68:83]
    v_mfma_f32_32x32x16_bf16 v[84:99], v[36:39], v[60:63], v[84:99]
    ds_read_b128 v[48:51], v247 offset:8192
    ds_read_b64_tr_b16 v[36:37], v249 offset:17920
    ds_read_b64_tr_b16 v[38:39], v249 offset:18560
    s_waitcnt lgkmcnt(6)
    v_mfma_f32_32x32x16_bf16 v[68:83], v[40:43], v[52:55], v[68:83]
    s_waitcnt lgkmcnt(3)
    v_mfma_f32_32x32x16_bf16 v[68:83], v[32:35], v[44:47], v[68:83]
    v_mfma_f32_32x32x16_bf16 v[84:99], v[32:35], v[60:63], v[84:99]
    s_waitcnt lgkmcnt(0)
    v_mfma_f32_32x32x16_bf16 v[68:83], v[36:39], v[48:51], v[68:83]
    v_subrev_u32 v244, 36864, v244
    v_subrev_u32 v245, 36864, v245
    v_subrev_u32 v246, 36864, v246
    v_subrev_u32 v247, 36864, v247
    v_subrev_u32 v248, 36864, v248
    v_subrev_u32 v249, 36864, v249
    s_cmp_lg_u32 s3, 0
    s_cbranch_scc1 L_p0w_2a
    v_mov_b32 v232, 0
    s_mov_b32 s53, 262144
    s_branch L_non_3w
L_non_3:
    buffer_load_dwordx2 v[234:235], v232, s[56:59], 0 offen sc1
L_non_3w:
    s_sub_u32 s53, s53, 1
    s_waitcnt vmcnt(0)
    v_readfirstlane_b32 s94, v234
    v_readfirstlane_b32 s95, v235
    s_cmp_eq_u32 s53, 0
    s_cbranch_scc1 L_non_3x
    s_cmp_eq_u32 s94, 0
    s_cbranch_scc1 L_non_3
L_non_3x:
    s_getreg_b32 s52, hwreg(HW_REG_XCC_ID, 0, 4)
    s_lshl_b32 s52, s52, 28
    s_xor_b32 s52, s52, s94
    s_and_b32 s6, s2, 7
    s_lshl_b32 s53, s6, 8
    s_add_u32 s53, s53, 786432
    s_lshr_b32 s6, s2, 3
    s_lshl_b32 s6, s6, 3
    v_mov_b32 v232, s6
    v_mov_b32 v236, s52
    v_mov_b32 v237, s95
    s_mov_b64 exec, 1
    buffer_store_dwordx2 v[236:237], v232, s[64:67], s53 offen sc1
    s_mov_b64 exec, -1
    v_lshlrev_b32 v232, 11, v1
    s_lshl_b32 s6, s2, 3
    s_add_u32 s6, s6, 819200
    s_mov_b32 exec_lo, 0xff
    s_mov_b32 exec_hi, 0x0
    buffer_store_dwordx2 v[234:235], v232, s[64:67], s6 offen sc1
    s_mov_b64 exec, -1
L_p0w_2a:
    s_barrier
    ds_read_b128 v[44:47], v244 offset:0
    ds_read_b64_tr_b16 v[32:33], v248 offset:0
    ds_read_b64_tr_b16 v[34:35], v248 offset:640
    ds_read_b128 v[48:51], v245 offset:0
    ds_read_b64_tr_b16 v[36:37], v249 offset:2560
    ds_read_b64_tr_b16 v[38:39], v249 offset:3200
    ds_read_b128 v[52:55], v246 offset:0
    ds_read_b64_tr_b16 v[40:41], v248 offset:5120
    ds_read_b64_tr_b16 v[42:43], v248 offset:5760
    s_waitcnt lgkmcnt(6)
    v_mfma_f32_32x32x16_bf16 v[68:83], v[32:35], v[44:47], v[68:83]
    v_mfma_f32_32x32x16_bf16 v[84:99], v[32:35], v[60:63], v[84:99]
    ds_read_b128 v[44:47], v247 offset:0
    ds_read_b64_tr_b16 v[32:33], v249 offset:7680
    ds_read_b64_tr_b16 v[34:35], v249 offset:8320
    s_waitcnt lgkmcnt(6)
    v_mfma_f32_32x32x16_bf16 v[68:83], v[36:39], v[48:51], v[68:83]
    ds_read_b128 v[48:51], v244 offset:8192
    ds_read_b64_tr_b16 v[36:37], v248 offset:10240
    ds_read_b64_tr_b16 v[38:39], v248 offset:10880
    s_waitcnt lgkmcnt(6)
    v_mfma_f32_32x32x16_bf16 v[68:83], v[40:43], v[52:55], v[68:83]
    v_mfma_f32_32x32x16_bf16 v[84:99], v[40:43], v[60:63], v[84:99]
    ds_read_b128 v[52:55], v245 offset:8192
    ds_read_b64_tr_b16 v[40:41], v249 offset:12800
    ds_read_b64_tr_b16 v[42:43], v249 offset:13440
    s_waitcnt lgkmcnt(6)
    v_mfma_f32_32x32x16_bf16 v[68:83], v[32:35], v[44:47], v[68:83]
    ds_read_b128 v[44:47], v246 offset:8192
    ds_read_b64_tr_b16 v[32:33], v248 offset:15360
    ds_read_b64_tr_b16 v[34:35], v248 offset:16000
    s_waitcnt lgkmcnt(6)
    v_mfma_f32_32x32x16_bf16 v[68:83], v[36:39], v[48:51], v[68:83]
    v_mfma_f32_32x32x16_bf16 v[84:99], v[36:39], v[60:63], v[84:99]
    ds_read_b128 v[48:51], v247 offset:8192
    ds_read_b64_tr_b16 v[36:37], v249 offset:17920
    ds_read_b64_tr_b16 v[38:39], v249 offset:18560
    s_waitcnt lgkmcnt(6)
    v_mfma_f32_32x32x16_bf16 v[68:83], v[40:43], v[52:55], v[68:83]
    s_waitcnt lgkmcnt(3)
    v_mfma_f32_32x32x16_bf16 v[68:83], v[32:35], v[44:47], v[68:83]
    v_mfma_f32_32x32x16_bf16 v[84:99], v[32:35], v[60:63], v[84:99]
    s_waitcnt lgkmcnt(0)
    v_mfma_f32_32x32x16_bf16 v[68:83], v[36:39], v[48:51], v[68:83]
    v_subrev_u32 v244, 36864, v244
    v_subrev_u32 v245, 36864, v245
    v_subrev_u32 v246, 36864, v246
    v_subrev_u32 v247, 36864, v247
    v_subrev_u32 v248, 36864, v248
    v_subrev_u32 v249, 36864, v249
    s_barrier
    ds_read_b128 v[44:47], v244 offset:0
    ds_read_b64_tr_b16 v[32:33], v248 offset:0
    ds_read_b64_tr_b16 v[34:35], v248 offset:640
    ds_read_b128 v[48:51], v245 offset:0
    ds_read_b64_tr_b16 v[36:37], v249 offset:2560
    ds_read_b64_tr_b16 v[38:39], v249 offset:3200
    ds_read_b128 v[52:55], v246 offset:0
    ds_read_b64_tr_b16 v[40:41], v248 offset:5120
    ds_read_b64_tr_b16 v[42:43], v248 offset:5760
    s_waitcnt lgkmcnt(6)
    v_mfma_f32_32x32x16_bf16 v[68:83], v[32:35], v[44:47], v[68:83]
    v_mfma_f32_32x32x16_bf16 v[84:99], v[32:35], v[60:63], v[84:99]
    ds_read_b128 v[44:47], v247 offset:0
    ds_read_b64_tr_b16 v[32:33], v249 offset:7680
    ds_read_b64_tr_b16 v[34:35], v249 offset:8320
    s_waitcnt lgkmcnt(6)
    v_mfma_f32_32x32x16_bf16 v[68:83], v[36:39], v[48:51], v[68:83]
    ds_read_b128 v[48:51], v244 offset:8192
    ds_read_b64_tr_b16 v[36:37], v248 offset:10240
    ds_read_b64_tr_b16 v[38:39], v248 offset:10880
    s_waitcnt lgkmcnt(6)
    v_mfma_f32_32x32x16_bf16 v[68:83], v[40:43], v[52:55], v[68:83]
    v_mfma_f32_32x32x16_bf16 v[84:99], v[40:43], v[60:63], v[84:99]
    ds_read_b128 v[52:55], v245 offset:8192
    ds_read_b64_tr_b16 v[40:41], v249 offset:12800
    ds_read_b64_tr_b16 v[42:43], v249 offset:13440
    s_waitcnt lgkmcnt(6)
    v_mfma_f32_32x32x16_bf16 v[68:83], v[32:35], v[44:47], v[68:83]
    ds_read_b128 v[44:47], v246 offset:8192
    ds_read_b64_tr_b16 v[32:33], v248 offset:15360
    ds_read_b64_tr_b16 v[34:35], v248 offset:16000
    s_waitcnt lgkmcnt(6)
    v_mfma_f32_32x32x16_bf16 v[68:83], v[36:39], v[48:51], v[68:83]
    v_mfma_f32_32x32x16_bf16 v[84:99], v[36:39], v[60:63], v[84:99]
    ds_read_b128 v[48:51], v247 offset:8192
    ds_read_b64_tr_b16 v[36:37], v249 offset:17920
    ds_read_b64_tr_b16 v[38:39], v249 offset:18560
    s_waitcnt lgkmcnt(6)
    v_mfma_f32_32x32x16_bf16 v[68:83], v[40:43], v[52:55], v[68:83]
    s_waitcnt lgkmcnt(3)
    v_mfma_f32_32x32x16_bf16 v[68:83], v[32:35], v[44:47], v[68:83]
    v_mfma_f32_32x32x16_bf16 v[84:99], v[32:35], v[60:63], v[84:99]
    s_waitcnt lgkmcnt(0)
    v_mfma_f32_32x32x16_bf16 v[68:83], v[36:39], v[48:51], v[68:83]
    v_subrev_u32 v244, 36864, v244
    v_subrev_u32 v245, 36864, v245
    v_subrev_u32 v246, 36864, v246
    v_subrev_u32 v247, 36864, v247
    v_subrev_u32 v248, 36864, v248
    v_subrev_u32 v249, 36864, v249
    s_cmp_lg_u32 s3, 3
    s_cbranch_scc1 L_p0w_5b
    v_mov_b32 v232, 0
    s_mov_b32 s53, 262144
    s_branch L_non_6w
L_non_6:
    buffer_load_dwordx2 v[234:235], v232, s[56:59], 0 offen sc1
L_non_6w:
    s_sub_u32 s53, s53, 1
    s_waitcnt vmcnt(0)
    v_readfirstlane_b32 s94, v234
    v_readfirstlane_b32 s95, v235
    s_cmp_eq_u32 s53, 0
    s_cbranch_scc1 L_non_6x
    s_cmp_eq_u32 s94, 0
    s_cbranch_scc1 L_non_6
L_non_6x:
    v_mov_b32 v232, 163832
    ds_write_b64 v232, v[234:235]
    v_lshlrev_b32 v232, 5, v1
    s_and_b32 s6, s2, 7
    s_lshl_b32 s6, s6, 11
    s_add_u32 s6, s6, 819200
    s_mov_b32 s53, 262144
L_p0w_5c:
    buffer_load_dwordx4 v[236:239], v232, s[64:67], s6 offen sc1
    buffer_load_dwordx4 v[240:243], v232, s[64:67], s6 offen offset:16 sc1
    s_sub_u32 s53, s53, 1
    s_cmp_eq_u32 s53, 0
    s_cbranch_scc1 L_p0w_5d
    s_waitcnt vmcnt(0)
    v_cmp_ne_u64 vcc, s[94:95], v[236:237]
    v_cmp_ne_u64 s[48:49], s[94:95], v[238:239]
    s_or_b64 vcc, vcc, s[48:49]
    v_cmp_ne_u64 s[48:49], s[94:95], v[240:241]
    s_or_b64 vcc, vcc, s[48:49]
    v_cmp_ne_u64 s[48:49], s[94:95], v[242:243]
    s_or_b64 vcc, vcc, s[48:49]
    s_cmp_lg_u64 vcc, 0
    s_cbranch_scc1 L_p0w_5c
L_p0w_5d:
    s_waitcnt lgkmcnt(0)
L_p0w_5b:
    s_barrier
    ds_read_b128 v[44:47], v244 offset:0
    ds_read_b64_tr_b16 v[32:33], v248 offset:0
    ds_read_b64_tr_b16 v[34:35], v248 offset:640
    ds_read_b128 v[48:51], v245 offset:0
    ds_read_b64_tr_b16 v[36:37], v249 offset:2560
    ds_read_b64_tr_b16 v[38:39], v249 offset:3200
    v_mov_b32 v232, 163832
    ds_read_b64 v[234:235], v232
    s_mov_b32 s48, 0
    s_add_u32 m0, s7, 135168
    s_nop 0
    buffer_load_dwordx4 v4, s[36:39], s48 offen offset:0 sc1 lds
    buffer_load_dwordx4 v4, s[36:39], s48 offen offset:1024 sc1 lds
    buffer_load_dwordx4 v4, s[36:39], s48 offen offset:2048 sc1 lds
    s_mov_b32 s44, s32
    s_mov_b32 s45, s33
    s_mov_b32 s46, 0x4000
    s_mov_b32 s47, 0x00020000
    v_add_u32 v232, s63, v11
    v_lshlrev_b32 v232, 3, v232
    v_xor_b32 v233, 0x100, v232
    buffer_load_dwordx2 v[236:237], v232, s[44:47], 0 offen sc1
    buffer_load_dwordx2 v[238:239], v233, s[44:47], 0 offen sc1
    s_waitcnt lgkmcnt(0)
    v_readfirstlane_b32 s94, v234
    v_readfirstlane_b32 s95, v235
    ds_read_b128 v[52:55], v246 offset:0
    ds_read_b64_tr_b16 v[40:41], v248 offset:5120
    ds_read_b64_tr_b16 v[42:43], v248 offset:5760
    s_waitcnt lgkmcnt(6)
    v_mfma_f32_32x32x16_bf16 v[68:83], v[32:35], v[44:47], v[68:83]
    v_mfma_f32_32x32x16_bf16 v[84:99], v[32:35], v[60:63], v[84:99]
    ds_read_b128 v[44:47], v247 offset:0
    ds_read_b64_tr_b16 v[32:33], v249 offset:7680
    ds_read_b64_tr_b16 v[34:35], v249 offset:8320
    s_waitcnt lgkmcnt(6)
    v_mfma_f32_32x32x16_bf16 v[68:83], v[36:39], v[48:51], v[68:83]
    ds_read_b128 v[48:51], v244 offset:8192
    ds_read_b64_tr_b16 v[36:37], v248 offset:10240
    ds_read_b64_tr_b16 v[38:39], v248 offset:10880
    s_waitcnt lgkmcnt(6)
    v_mfma_f32_32x32x16_bf16 v[68:83], v[40:43], v[52:55], v[68:83]
    v_mfma_f32_32x32x16_bf16 v[84:99], v[40:43], v[60:63], v[84:99]
    ds_read_b128 v[52:55], v245 offset:8192
    ds_read_b64_tr_b16 v[40:41], v249 offset:12800
    ds_read_b64_tr_b16 v[42:43], v249 offset:13440
    s_waitcnt lgkmcnt(6)
    v_mfma_f32_32x32x16_bf16 v[68:83], v[32:35], v[44:47], v[68:83]
    ds_read_b128 v[44:47], v246 offset:8192
    ds_read_b64_tr_b16 v[32:33], v248 offset:15360
    ds_read_b64_tr_b16 v[34:35], v248 offset:16000
    s_waitcnt lgkmcnt(6)
    v_mfma_f32_32x32x16_bf16 v[68:83], v[36:39], v[48:51], v[68:83]
    v_mfma_f32_32x32x16_bf16 v[84:99], v[36:39], v[60:63], v[84:99]
    ds_read_b128 v[48:51], v247 offset:8192
    ds_read_b64_tr_b16 v[36:37], v249 offset:17920
    ds_read_b64_tr_b16 v[38:39], v249 offset:18560
    s_waitcnt lgkmcnt(6)
    v_mfma_f32_32x32x16_bf16 v[68:83], v[40:43], v[52:55], v[68:83]
    s_waitcnt lgkmcnt(3)
    v_mfma_f32_32x32x16_bf16 v[68:83], v[32:35], v[44:47], v[68:83]
    v_mfma_f32_32x32x16_bf16 v[84:99], v[32:35], v[60:63], v[84:99]
    s_waitcnt lgkmcnt(0)
    v_mfma_f32_32x32x16_bf16 v[68:83], v[36:39], v[48:51], v[68:83]
    v_add_u32 v244, 73728, v244
    v_add_u32 v245, 73728, v245
    v_add_u32 v246, 73728, v246
    v_add_u32 v247, 73728, v247
    v_add_u32 v248, 73728, v248
    v_add_u32 v249, 73728, v249
    s_barrier
    ds_read_b128 v[44:47], v244 offset:0
    ds_read_b64_tr_b16 v[32:33], v248 offset:0
    ds_read_b64_tr_b16 v[34:35], v248 offset:640
    ds_read_b128 v[48:51], v245 offset:0
    ds_read_b64_tr_b16 v[36:37], v249 offset:2560
    ds_read_b64_tr_b16 v[38:39], v249 offset:3200
    ds_read_b128 v[52:55], v246 offset:0
    ds_read_b64_tr_b16 v[40:41], v248 offset:5120
    ds_read_b64_tr_b16 v[42:43], v248 offset:5760
    s_waitcnt lgkmcnt(6)
    v_mfma_f32_32x32x16_bf16 v[68:83], v[32:35], v[44:47], v[68:83]
    v_mfma_f32_32x32x16_bf16 v[84:99], v[32:35], v[60:63], v[84:99]
    ds_read_b128 v[44:47], v247 offset:0
    ds_read_b64_tr_b16 v[32:33], v249 offset:7680
    ds_read_b64_tr_b16 v[34:35], v249 offset:8320
    s_waitcnt lgkmcnt(6)
    v_mfma_f32_32x32x16_bf16 v[68:83], v[36:39], v[48:51], v[68:83]
    ds_read_b128 v[48:51], v244 offset:8192
    ds_read_b64_tr_b16 v[36:37], v248 offset:10240
    ds_read_b64_tr_b16 v[38:39], v248 offset:10880
    s_waitcnt lgkmcnt(6)
    v_mfma_f32_32x32x16_bf16 v[68:83], v[40:43], v[52:55], v[68:83]
    v_mfma_f32_32x32x16_bf16 v[84:99], v[40:43], v[60:63], v[84:99]
    ds_read_b128 v[52:55], v245 offset:8192
    ds_read_b64_tr_b16 v[40:41], v249 offset:12800
    ds_read_b64_tr_b16 v[42:43], v249 offset:13440
    s_waitcnt lgkmcnt(6)
    v_mfma_f32_32x32x16_bf16 v[68:83], v[32:35], v[44:47], v[68:83]
    ds_read_b128 v[44:47], v246 offset:8192
    ds_read_b64_tr_b16 v[32:33], v248 offset:15360
    ds_read_b64_tr_b16 v[34:35], v248 offset:16000
    s_waitcnt lgkmcnt(6)
    v_mfma_f32_32x32x16_bf16 v[68:83], v[36:39], v[48:51], v[68:83]
    v_mfma_f32_32x32x16_bf16 v[84:99], v[36:39], v[60:63], v[84:99]
    ds_read_b128 v[48:51], v247 offset:8192
    ds_read_b64_tr_b16 v[36:37], v249 offset:17920
    ds_read_b64_tr_b16 v[38:39], v249 offset:18560
    s_waitcnt lgkmcnt(6)
    v_mfma_f32_32x32x16_bf16 v[68:83], v[40:43], v[52:55], v[68:83]
    s_waitcnt lgkmcnt(3)
    v_mfma_f32_32x32x16_bf16 v[68:83], v[32:35], v[44:47], v[68:83]
    v_mfma_f32_32x32x16_bf16 v[84:99], v[32:35], v[60:63], v[84:99]
    s_waitcnt lgkmcnt(0)
    v_mfma_f32_32x32x16_bf16 v[68:83], v[36:39], v[48:51], v[68:83]
    s_branch L_p0x
L_p0ql:
    s_waitcnt vmcnt(9)
    s_barrier
    ds_read_b128 v[44:47], v244 offset:0
    ds_read_b64_tr_b16 v[32:33], v248 offset:0
    ds_read_b64_tr_b16 v[34:35], v248 offset:640
    ds_read_b128 v[48:51], v245 offset:0
    ds_read_b64_tr_b16 v[36:37], v249 offset:2560
    ds_read_b64_tr_b16 v[38:39], v249 offset:3200
    s_add_u32 m0, s50, 36864
    s_add_u32 s6, s49, 0
    buffer_load_dwordx4 v132, s[40:43], s6 offen lds
    s_add_u32 m0, s50, 37888
    s_add_u32 s6, s49, 0
    buffer_load_dwordx4 v133, s[40:43], s6 offen lds
    ds_read_b128 v[52:55], v246 offset:0
    ds_read_b64_tr_b16 v[40:41], v248 offset:5120
    ds_read_b64_tr_b16 v[42:43], v248 offset:5760
    s_waitcnt lgkmcnt(6)
    v_mfma_f32_32x32x16_bf16 v[68:83], v[32:35], v[44:47], 0
    v_mfma_f32_32x32x16_bf16 v[84:99], v[32:35], v[60:63], 0
    s_add_u32 m0, s50, 45056
    s_add_u32 s6, s49, 128
    buffer_load_dwordx4 v132, s[40:43], s6 offen lds
    s_add_u32 m0, s50, 46080
    s_add_u32 s6, s49, 128
    buffer_load_dwordx4 v133, s[40:43], s6 offen lds
    ds_read_b128 v[44:47], v247 offset:0
    ds_read_b64_tr_b16 v[32:33], v249 offset:7680
    ds_read_b64_tr_b16 v[34:35], v249 offset:8320
    s_waitcnt lgkmcnt(6)
    v_mfma_f32_32x32x16_bf16 v[68:83], v[36:39], v[48:51], v[68:83]
    s_add_u32 m0, s51, 36864
    s_mul_i32 s6, s49, 640
    buffer_load_dwordx4 v134, s[44:47], s6 offen lds
    s_add_u32 m0, s51, 37888
    s_mul_i32 s6, s49, 640
    buffer_load_dwordx4 v135, s[44:47], s6 offen lds
    ds_read_b128 v[48:51], v244 offset:8192
    ds_read_b64_tr_b16 v[36:37], v248 offset:10240
    ds_read_b64_tr_b16 v[38:39], v248 offset:10880
    s_waitcnt lgkmcnt(6)
    v_mfma_f32_32x32x16_bf16 v[68:83], v[40:43], v[52:55], v[68:83]
    v_mfma_f32_32x32x16_bf16 v[84:99], v[40:43], v[60:63], v[84:99]
    s_add_u32 m0, s51, 38912
    s_mul_i32 s6, s49, 640
    buffer_load_dwordx4 v136, s[44:47], s6 offen lds
    s_add_u32 m0, s51, 39936
    s_mul_i32 s6, s49, 640
    buffer_load_dwordx4 v137, s[44:47], s6 offen lds
    ds_read_b128 v[52:55], v245 offset:8192
    ds_read_b64_tr_b16 v[40:41], v249 offset:12800
    ds_read_b64_tr_b16 v[42:43], v249 offset:13440
    s_waitcnt lgkmcnt(6)
    v_mfma_f32_32x32x16_bf16 v[68:83], v[32:35], v[44:47], v[68:83]
    s_add_u32 m0, s51, 40960
    s_mul_i32 s6, s49, 640
    buffer_load_dwordx4 v138, s[44:47], s6 offen lds
    s_add_u32 s49, s49, 256
    s_cmp_eq_u32 s49, 1280
    s_cselect_b32 s49, 0, s49
    s_add_u32 m0, s50, 0
    s_add_u32 s6, s49, 0
    buffer_load_dwordx4 v132, s[40:43], s6 offen lds
    ds_read_b128 v[44:47], v246 offset:8192
    ds_read_b64_tr_b16 v[32:33], v248 offset:15360
    ds_read_b64_tr_b16 v[34:35], v248 offset:16000
    s_waitcnt lgkmcnt(6)
    v_mfma_f32_32x32x16_bf16 v[68:83], v[36:39], v[48:51], v[68:83]
    v_mfma_f32_32x32x16_bf16 v[84:99], v[36:39], v[60:63], v[84:99]
    s_add_u32 m0, s50, 1024
    s_add_u32 s6, s49, 0
    buffer_load_dwordx4 v133, s[40:43], s6 offen lds
    s_add_u32 m0, s50, 8192
    s_add_u32 s6, s49, 128
    buffer_load_dwordx4 v132, s[40:43], s6 offen lds
    ds_read_b128 v[48:51], v247 offset:8192
    ds_read_b64_tr_b16 v[36:37], v249 offset:17920
    ds_read_b64_tr_b16 v[38:39], v249 offset:18560
    s_waitcnt lgkmcnt(6)
    v_mfma_f32_32x32x16_bf16 v[68:83], v[40:43], v[52:55], v[68:83]
    s_add_u32 m0, s50, 9216
    s_add_u32 s6, s49, 128
    buffer_load_dwordx4 v133, s[40:43], s6 offen lds
    s_add_u32 m0, s51, 0
    s_mul_i32 s6, s49, 640
    buffer_load_dwordx4 v134, s[44:47], s6 offen lds
    s_waitcnt lgkmcnt(3)
    v_mfma_f32_32x32x16_bf16 v[68:83], v[32:35], v[44:47], v[68:83]
    v_mfma_f32_32x32x16_bf16 v[84:99], v[32:35], v[60:63], v[84:99]
    s_add_u32 m0, s51, 1024
    s_mul_i32 s6, s49, 640
    buffer_load_dwordx4 v135, s[44:47], s6 offen lds
    s_add_u32 m0, s51, 2048
    s_mul_i32 s6, s49, 640
    buffer_load_dwordx4 v136, s[44:47], s6 offen lds
    s_waitcnt lgkmcnt(0)
    v_mfma_f32_32x32x16_bf16 v[68:83], v[36:39], v[48:51], v[68:83]
    s_add_u32 m0, s51, 3072
    s_mul_i32 s6, s49, 640
    buffer_load_dwordx4 v137, s[44:47], s6 offen lds
    s_add_u32 m0, s51, 4096
    s_mul_i32 s6, s49, 640
    buffer_load_dwordx4 v138, s[44:47], s6 offen lds
    s_add_u32 s49, s49, 256
    s_cmp_eq_u32 s49, 1280
    s_cselect_b32 s49, 0, s49
    v_subrev_u32 v244, 36864, v244
    v_subrev_u32 v245, 36864, v245
    v_subrev_u32 v246, 36864, v246
    v_subrev_u32 v247, 36864, v247
    v_subrev_u32 v248, 36864, v248
    v_subrev_u32 v249, 36864, v249
    s_waitcnt vmcnt(18)
    s_barrier
    ds_read_b128 v[44:47], v244 offset:0
    ds_read_b64_tr_b16 v[32:33], v248 offset:0
    ds_read_b64_tr_b16 v[34:35], v248 offset:640
    ds_read_b128 v[48:51], v245 offset:0
    ds_read_b64_tr_b16 v[36:37], v249 offset:2560
    ds_read_b64_tr_b16 v[38:39], v249 offset:3200
    ds_read_b128 v[52:55], v246 offset:0
    ds_read_b64_tr_b16 v[40:41], v248 offset:5120
    ds_read_b64_tr_b16 v[42:43], v248 offset:5760
    s_waitcnt lgkmcnt(6)
    v_mfma_f32_32x32x16_bf16 v[68:83], v[32:35], v[44:47], v[68:83]
    v_mfma_f32_32x32x16_bf16 v[84:99], v[32:35], v[60:63], v[84:99]
    ds_read_b128 v[44:47], v247 offset:0
    ds_read_b64_tr_b16 v[32:33], v249 offset:7680
    ds_read_b64_tr_b16 v[34:35], v249 offset:8320
    s_waitcnt lgkmcnt(6)
    v_mfma_f32_32x32x16_bf16 v[68:83], v[36:39], v[48:51], v[68:83]
    ds_read_b128 v[48:51], v244 offset:8192
    ds_read_b64_tr_b16 v[36:37], v248 offset:10240
    ds_read_b64_tr_b16 v[38:39], v248 offset:10880
    s_waitcnt lgkmcnt(6)
    v_mfma_f32_32x32x16_bf16 v[68:83], v[40:43], v[52:55], v[68:83]
    v_mfma_f32_32x32x16_bf16 v[84:99], v[40:43], v[60:63], v[84:99]
    ds_read_b128 v[52:55], v245 offset:8192
    ds_read_b64_tr_b16 v[40:41], v249 offset:12800
    ds_read_b64_tr_b16 v[42:43], v249 offset:13440
    s_waitcnt lgkmcnt(6)
    v_mfma_f32_32x32x16_bf16 v[68:83], v[32:35], v[44:47], v[68:83]
    ds_read_b128 v[44:47], v246 offset:8192
    ds_read_b64_tr_b16 v[32:33], v248 offset:15360
    ds_read_b64_tr_b16 v[34:35], v248 offset:16000
    s_waitcnt lgkmcnt(6)
    v_mfma_f32_32x32x16_bf16 v[68:83], v[36:39], v[48:51], v[68:83]
    v_mfma_f32_32x32x16_bf16 v[84:99], v[36:39], v[60:63], v[84:99]
    ds_read_b128 v[48:51], v247 offset:8192
    ds_read_b64_tr_b16 v[36:37], v249 offset:17920
    ds_read_b64_tr_b16 v[38:39], v249 offset:18560
    s_waitcnt lgkmcnt(6)
    v_mfma_f32_32x32x16_bf16 v[68:83], v[40:43], v[52:55], v[68:83]
    s_waitcnt lgkmcnt(3)
    v_mfma_f32_32x32x16_bf16 v[68:83], v[32:35], v[44:47], v[68:83]
    v_mfma_f32_32x32x16_bf16 v[84:99], v[32:35], v[60:63], v[84:99]
    s_waitcnt lgkmcnt(0)
    v_mfma_f32_32x32x16_bf16 v[68:83], v[36:39], v[48:51], v[68:83]
    v_subrev_u32 v244, 36864, v244
    v_subrev_u32 v245, 36864, v245
    v_subrev_u32 v246, 36864, v246
    v_subrev_u32 v247, 36864, v247
    v_subrev_u32 v248, 36864, v248
    v_subrev_u32 v249, 36864, v249
    s_waitcnt vmcnt(9)
    s_barrier
    ds_read_b128 v[44:47], v244 offset:0
    ds_read_b64_tr_b16 v[32:33], v248 offset:0
    ds_read_b64_tr_b16 v[34:35], v248 offset:640
    ds_read_b128 v[48:51], v245 offset:0
    ds_read_b64_tr_b16 v[36:37], v249 offset:2560
    ds_read_b64_tr_b16 v[38:39], v249 offset:3200
    s_add_u32 m0, s50, 73728
    s_add_u32 s6, s49, 0
    buffer_load_dwordx4 v132, s[40:43], s6 offen lds
    ds_read_b128 v[52:55], v246 offset:0
    ds_read_b64_tr_b16 v[40:41], v248 offset:5120
    ds_read_b64_tr_b16 v[42:43], v248 offset:5760
    s_waitcnt lgkmcnt(6)
    v_mfma_f32_32x32x16_bf16 v[68:83], v[32:35], v[44:47], v[68:83]
    v_mfma_f32_32x32x16_bf16 v[84:99], v[32:35], v[60:63], v[84:99]
    s_add_u32 m0, s50, 74752
    s_add_u32 s6, s49, 0
    buffer_load_dwordx4 v133, s[40:43], s6 offen lds
    ds_read_b128 v[44:47], v247 offset:0
    ds_read_b64_tr_b16 v[32:33], v249 offset:7680
    ds_read_b64_tr_b16 v[34:35], v249 offset:8320
    s_waitcnt lgkmcnt(6)
    v_mfma_f32_32x32x16_bf16 v[68:83], v[36:39], v[48:51], v[68:83]
    s_add_u32 m0, s50, 81920
    s_add_u32 s6, s49, 128
    buffer_load_dwordx4 v132, s[40:43], s6 offen lds
    ds_read_b128 v[48:51], v244 offset:8192
    ds_read_b64_tr_b16 v[36:37], v248 offset:10240
    ds_read_b64_tr_b16 v[38:39], v248 offset:10880
    s_waitcnt lgkmcnt(6)
    v_mfma_f32_32x32x16_bf16 v[68:83], v[40:43], v[52:55], v[68:83]
    v_mfma_f32_32x32x16_bf16 v[84:99], v[40:43], v[60:63], v[84:99]
    s_add_u32 m0, s50, 82944
    s_add_u32 s6, s49, 128
    buffer_load_dwordx4 v133, s[40:43], s6 offen lds
    ds_read_b128 v[52:55], v245 offset:8192
    ds_read_b64_tr_b16 v[40:41], v249 offset:12800
    ds_read_b64_tr_b16 v[42:43], v249 offset:13440
    s_waitcnt lgkmcnt(6)
    v_mfma_f32_32x32x16_bf16 v[68:83], v[32:35], v[44:47], v[68:83]
    s_add_u32 m0, s51, 73728
    s_mul_i32 s6, s49, 640
    buffer_load_dwordx4 v134, s[44:47], s6 offen lds
    ds_read_b128 v[44:47], v246 offset:8192
    ds_read_b64_tr_b16 v[32:33], v248 offset:15360
    ds_read_b64_tr_b16 v[34:35], v248 offset:16000
    s_waitcnt lgkmcnt(6)
    v_mfma_f32_32x32x16_bf16 v[68:83], v[36:39], v[48:51], v[68:83]
    v_mfma_f32_32x32x16_bf16 v[84:99], v[36:39], v[60:63], v[84:99]
    s_add_u32 m0, s51, 74752
    s_mul_i32 s6, s49, 640
    buffer_load_dwordx4 v135, s[44:47], s6 offen lds
    ds_read_b128 v[48:51], v247 offset:8192
    ds_read_b64_tr_b16 v[36:37], v249 offset:17920
    ds_read_b64_tr_b16 v[38:39], v249 offset:18560
    s_waitcnt lgkmcnt(6)
    v_mfma_f32_32x32x16_bf16 v[68:83], v[40:43], v[52:55], v[68:83]
    s_add_u32 m0, s51, 75776
    s_mul_i32 s6, s49, 640
    buffer_load_dwordx4 v136, s[44:47], s6 offen lds
    s_waitcnt lgkmcnt(3)
    v_mfma_f32_32x32x16_bf16 v[68:83], v[32:35], v[44:47], v[68:83]
    v_mfma_f32_32x32x16_bf16 v[84:99], v[32:35], v[60:63], v[84:99]
    s_add_u32 m0, s51, 76800
    s_mul_i32 s6, s49, 640
    buffer_load_dwordx4 v137, s[44:47], s6 offen lds
    s_waitcnt lgkmcnt(0)
    v_mfma_f32_32x32x16_bf16 v[68:83], v[36:39], v[48:51], v[68:83]
    s_add_u32 m0, s51, 77824
    s_mul_i32 s6, s49, 640
    buffer_load_dwordx4 v138, s[44:47], s6 offen lds
    s_add_u32 s49, s49, 256
    s_cmp_eq_u32 s49, 1280
    s_cselect_b32 s49, 0, s49
    v_subrev_u32 v244, 36864, v244
    v_subrev_u32 v245, 36864, v245
    v_subrev_u32 v246, 36864, v246
    v_subrev_u32 v247, 36864, v247
    v_subrev_u32 v248, 36864, v248
    v_subrev_u32 v249, 36864, v249
    s_waitcnt vmcnt(9)
    s_barrier
    ds_read_b128 v[44:47], v244 offset:0
    ds_read_b64_tr_b16 v[32:33], v248 offset:0
    ds_read_b64_tr_b16 v[34:35], v248 offset:640
    ds_read_b128 v[48:51], v245 offset:0
    ds_read_b64_tr_b16 v[36:37], v249 offset:2560
    ds_read_b64_tr_b16 v[38:39], v249 offset:3200
    v_mov_b32 v232, 163832
    ds_read_b64 v[234:235], v232
    s_mov_b32 s48, 0
    s_add_u32 m0, s7, 135168
    s_nop 0
    buffer_load_dwordx4 v4, s[36:39], s48 offen offset:0 sc1 lds
    buffer_load_dwordx4 v4, s[36:39], s48 offen offset:1024 sc1 lds
    buffer_load_dwordx4 v4, s[36:39], s48 offen offset:2048 sc1 lds
    s_mov_b32 s44, s32
    s_mov_b32 s45, s33
    s_mov_b32 s46, 0x4000
    s_mov_b32 s47, 0x00020000
    v_add_u32 v232, s63, v11
    v_lshlrev_b32 v232, 3, v232
    v_xor_b32 v233, 0x100, v232
    buffer_load_dwordx2 v[236:237], v232, s[44:47], 0 offen sc1
    buffer_load_dwordx2 v[238:239], v233, s[44:47], 0 offen sc1
    s_waitcnt lgkmcnt(0)
    v_readfirstlane_b32 s94, v234
    v_readfirstlane_b32 s95, v235
    ds_read_b128 v[52:55], v246 offset:0
    ds_read_b64_tr_b16 v[40:41], v248 offset:5120
    ds_read_b64_tr_b16 v[42:43], v248 offset:5760
    s_waitcnt lgkmcnt(6)
    v_mfma_f32_32x32x16_bf16 v[68:83], v[32:35], v[44:47], v[68:83]
    v_mfma_f32_32x32x16_bf16 v[84:99], v[32:35], v[60:63], v[84:99]
    ds_read_b128 v[44:47], v247 offset:0
    ds_read_b64_tr_b16 v[32:33], v249 offset:7680
    ds_read_b64_tr_b16 v[34:35], v249 offset:8320
    s_waitcnt lgkmcnt(6)
    v_mfma_f32_32x32x16_bf16 v[68:83], v[36:39], v[48:51], v[68:83]
    ds_read_b128 v[48:51], v244 offset:8192
    ds_read_b64_tr_b16 v[36:37], v248 offset:10240
    ds_read_b64_tr_b16 v[38:39], v248 offset:10880
    s_waitcnt lgkmcnt(6)
    v_mfma_f32_32x32x16_bf16 v[68:83], v[40:43], v[52:55], v[68:83]
    v_mfma_f32_32x32x16_bf16 v[84:99], v[40:43], v[60:63], v[84:99]
    ds_read_b128 v[52:55], v245 offset:8192
    ds_read_b64_tr_b16 v[40:41], v249 offset:12800
    ds_read_b64_tr_b16 v[42:43], v249 offset:13440
    s_waitcnt lgkmcnt(6)
    v_mfma_f32_32x32x16_bf16 v[68:83], v[32:35], v[44:47], v[68:83]
    ds_read_b128 v[44:47], v246 offset:8192
    ds_read_b64_tr_b16 v[32:33], v248 offset:15360
    ds_read_b64_tr_b16 v[34:35], v248 offset:16000
    s_waitcnt lgkmcnt(6)
    v_mfma_f32_32x32x16_bf16 v[68:83], v[36:39], v[48:51], v[68:83]
    v_mfma_f32_32x32x16_bf16 v[84:99], v[36:39], v[60:63], v[84:99]
    ds_read_b128 v[48:51], v247 offset:8192
    ds_read_b64_tr_b16 v[36:37], v249 offset:17920
    ds_read_b64_tr_b16 v[38:39], v249 offset:18560
    s_waitcnt lgkmcnt(6)
    v_mfma_f32_32x32x16_bf16 v[68:83], v[40:43], v[52:55], v[68:83]
    s_waitcnt lgkmcnt(3)
    v_mfma_f32_32x32x16_bf16 v[68:83], v[32:35], v[44:47], v[68:83]
    v_mfma_f32_32x32x16_bf16 v[84:99], v[32:35], v[60:63], v[84:99]
    s_waitcnt lgkmcnt(0)
    v_mfma_f32_32x32x16_bf16 v[68:83], v[36:39], v[48:51], v[68:83]
    v_add_u32 v244, 73728, v244
    v_add_u32 v245, 73728, v245
    v_add_u32 v246, 73728, v246
    v_add_u32 v247, 73728, v247
    v_add_u32 v248, 73728, v248
    v_add_u32 v249, 73728, v249
    s_waitcnt vmcnt(5)
    s_barrier
    ds_read_b128 v[44:47], v244 offset:0
    ds_read_b64_tr_b16 v[32:33], v248 offset:0
    ds_read_b64_tr_b16 v[34:35], v248 offset:640
    ds_read_b128 v[48:51], v245 offset:0
    ds_read_b64_tr_b16 v[36:37], v249 offset:2560
    ds_read_b64_tr_b16 v[38:39], v249 offset:3200
    ds_read_b128 v[52:55], v246 offset:0
    ds_read_b64_tr_b16 v[40:41], v248 offset:5120
    ds_read_b64_tr_b16 v[42:43], v248 offset:5760
    s_waitcnt lgkmcnt(6)
    v_mfma_f32_32x32x16_bf16 v[68:83], v[32:35], v[44:47], v[68:83]
    v_mfma_f32_32x32x16_bf16 v[84:99], v[32:35], v[60:63], v[84:99]
    ds_read_b128 v[44:47], v247 offset:0
    ds_read_b64_tr_b16 v[32:33], v249 offset:7680
    ds_read_b64_tr_b16 v[34:35], v249 offset:8320
    s_waitcnt lgkmcnt(6)
    v_mfma_f32_32x32x16_bf16 v[68:83], v[36:39], v[48:51], v[68:83]
    ds_read_b128 v[48:51], v244 offset:8192
    ds_read_b64_tr_b16 v[36:37], v248 offset:10240
    ds_read_b64_tr_b16 v[38:39], v248 offset:10880
    s_waitcnt lgkmcnt(6)
    v_mfma_f32_32x32x16_bf16 v[68:83], v[40:43], v[52:55], v[68:83]
    v_mfma_f32_32x32x16_bf16 v[84:99], v[40:43], v[60:63], v[84:99]
    ds_read_b128 v[52:55], v245 offset:8192
    ds_read_b64_tr_b16 v[40:41], v249 offset:12800
    ds_read_b64_tr_b16 v[42:43], v249 offset:13440
    s_waitcnt lgkmcnt(6)
    v_mfma_f32_32x32x16_bf16 v[68:83], v[32:35], v[44:47], v[68:83]
    ds_read_b128 v[44:47], v246 offset:8192
    ds_read_b64_tr_b16 v[32:33], v248 offset:15360
    ds_read_b64_tr_b16 v[34:35], v248 offset:16000
    s_waitcnt lgkmcnt(6)
    v_mfma_f32_32x32x16_bf16 v[68:83], v[36:39], v[48:51], v[68:83]
    v_mfma_f32_32x32x16_bf16 v[84:99], v[36:39], v[60:63], v[84:99]
    ds_read_b128 v[48:51], v247 offset:8192
    ds_read_b64_tr_b16 v[36:37], v249 offset:17920
    ds_read_b64_tr_b16 v[38:39], v249 offset:18560
    s_waitcnt lgkmcnt(6)
    v_mfma_f32_32x32x16_bf16 v[68:83], v[40:43], v[52:55], v[68:83]
    s_waitcnt lgkmcnt(3)
    v_mfma_f32_32x32x16_bf16 v[68:83], v[32:35], v[44:47], v[68:83]
    v_mfma_f32_32x32x16_bf16 v[84:99], v[32:35], v[60:63], v[84:99]
    s_waitcnt lgkmcnt(0)
    v_mfma_f32_32x32x16_bf16 v[68:83], v[36:39], v[48:51], v[68:83]
L_p0x:
    s_mul_i32 s6, s3, 3072
    s_add_u32 s6, s6, 36864
    v_add_u32 v226, s6, v8
    s_lshl_b32 s6, s3, 7
    s_add_u32 s6, s6, 61440
    v_lshl_add_u32 v227, v12, 6, s6
    s_xor_b32 s52, s3, 1
    s_mul_i32 s6, s52, 3072
    s_add_u32 s6, s6, 36864
    v_add_u32 v228, s6, v8
    s_lshl_b32 s6, s52, 7
    s_add_u32 s6, s6, 61440
    v_lshl_add_u32 v229, v12, 6, s6
    s_nop 3
    ds_write_b128 v227, v[84:87] offset:0
    ds_write_b128 v227, v[88:91] offset:16
    ds_write_b128 v227, v[92:95] offset:32
    ds_write_b128 v226, v[68:71] offset:0
    ds_write_b128 v226, v[72:75] offset:1024
    ds_write_b128 v226, v[76:79] offset:2048
    s_waitcnt vmcnt(0) lgkmcnt(0)
    s_barrier
    s_mov_b32 s48, 22528
    s_add_u32 m0, s7, 86016
    s_nop 0
    buffer_load_dwordx4 v4, s[36:39], s48 offen offset:0 sc1 lds
    buffer_load_dwordx4 v4, s[36:39], s48 offen offset:1024 sc1 lds
    buffer_load_dwordx4 v4, s[36:39], s48 offen offset:2048 sc1 lds
    ds_read_b128 v[152:155], v229 offset:0
    ds_read_b128 v[156:159], v229 offset:16
    ds_read_b128 v[160:163], v229 offset:32
    ds_read_b128 v[140:143], v228 offset:0
    ds_read_b128 v[144:147], v228 offset:1024
    ds_read_b128 v[148:151], v228 offset:2048
    s_waitcnt lgkmcnt(3)
    v_pk_add_f32 v[84:85], v[84:85], v[152:153]
    v_pk_add_f32 v[86:87], v[86:87], v[154:155]
    v_pk_add_f32 v[88:89], v[88:89], v[156:157]
    v_pk_add_f32 v[90:91], v[90:91], v[158:159]
    v_pk_add_f32 v[92:93], v[92:93], v[160:161]
    v_pk_add_f32 v[94:95], v[94:95], v[162:163]
    v_fma_f32 v68, -v236, v84, v68
    v_mul_f32 v68, v68, v237
    v_fma_f32 v69, -v236, v85, v69
    v_mul_f32 v69, v69, v237
    v_fma_f32 v70, -v236, v86, v70
    v_mul_f32 v70, v70, v237
    v_fma_f32 v71, -v236, v87, v71
    v_mul_f32 v71, v71, v237
    v_fma_f32 v72, -v236, v88, v72
    v_mul_f32 v72, v72, v237
    v_fma_f32 v73, -v236, v89, v73
    v_mul_f32 v73, v73, v237
    v_fma_f32 v74, -v236, v90, v74
    v_mul_f32 v74, v74, v237
    v_fma_f32 v75, -v236, v91, v75
    v_mul_f32 v75, v75, v237
    v_fma_f32 v76, -v236, v92, v76
    v_mul_f32 v76, v76, v237
    v_fma_f32 v77, -v236, v93, v77
    v_mul_f32 v77, v77, v237
    v_fma_f32 v78, -v236, v94, v78
    v_mul_f32 v78, v78, v237
    v_fma_f32 v79, -v236, v95, v79
    v_mul_f32 v79, v79, v237
    v_cvt_pk_bf16_f32 v20, v68, v69
    v_cvt_pk_bf16_f32 v21, v70, v71
    v_cvt_pk_bf16_f32 v22, v72, v73
    v_cvt_pk_bf16_f32 v23, v74, v75
    v_cvt_pk_bf16_f32 v24, v76, v77
    v_cvt_pk_bf16_f32 v25, v78, v79
    s_waitcnt lgkmcnt(0)
    v_fma_f32 v140, -v238, v84, v140
    v_mul_f32 v140, v140, v239
    v_fma_f32 v141, -v238, v85, v141
    v_mul_f32 v141, v141, v239
    v_fma_f32 v142, -v238, v86, v142
    v_mul_f32 v142, v142, v239
    v_fma_f32 v143, -v238, v87, v143
    v_mul_f32 v143, v143, v239
    v_fma_f32 v144, -v238, v88, v144
    v_mul_f32 v144, v144, v239
    v_fma_f32 v145, -v238, v89, v145
    v_mul_f32 v145, v145, v239
    v_fma_f32 v146, -v238, v90, v146
    v_mul_f32 v146, v146, v239
    v_fma_f32 v147, -v238, v91, v147
    v_mul_f32 v147, v147, v239
    v_fma_f32 v148, -v238, v92, v148
    v_mul_f32 v148, v148, v239
    v_fma_f32 v149, -v238, v93, v149
    v_mul_f32 v149, v149, v239
    v_fma_f32 v150, -v238, v94, v150
    v_mul_f32 v150, v150, v239
    v_fma_f32 v151, -v238, v95, v151
    v_mul_f32 v151, v151, v239
    v_cvt_pk_bf16_f32 v28, v140, v141
    v_cvt_pk_bf16_f32 v29, v142, v143
    v_cvt_pk_bf16_f32 v30, v144, v145
    v_cvt_pk_bf16_f32 v31, v146, v147
    v_cvt_pk_bf16_f32 v26, v148, v149
    v_cvt_pk_bf16_f32 v27, v150, v151
    s_add_u32 s44, s32, 0x300000
    s_addc_u32 s45, s33, 0
    s_mov_b32 s46, 0x280000
    s_mov_b32 s47, 0x00020000
    s_add_u32 s68, s32, 0x1000000
    s_addc_u32 s69, s33, 0
    s_mov_b32 s70, 0x494000
    s_mov_b32 s71, 0x00020000
    s_mov_b32 s56, s16
    s_mov_b32 s57, s17
    s_mov_b32 s58, 0xc8000
    s_mov_b32 s59, 0x00020000
    s_add_u32 s50, s97, 135168
    v_mul_lo_u32 v24, v24, v15
    v_mul_lo_u32 v25, v25, v15
    v_mul_lo_u32 v26, v26, v15
    v_mul_lo_u32 v27, v27, v15
    ds_read_b128 v[38:41], v5 offset:0
    ds_read_b64 v[42:43], v6 offset:0
    v_add_u32 v5, s50, v8
    v_add_u32 v6, s50, v9
    ds_read_b128 v[32:35], v5 offset:0
    ds_read_b64 v[36:37], v6 offset:0
    ds_read_b128 v[44:47], v7 offset:0
    ds_read_b128 v[48:51], v7 offset:768
    s_waitcnt lgkmcnt(4)
    v_mfma_f32_32x32x16_bf16 v[68:83], v[38:41], v[20:23], 0
    v_mfma_f32_32x32x8_bf16 v[68:83], v[42:43], v[24:25], v[68:83]
    v_mfma_f32_32x32x16_bf16 v[84:99], v[38:41], v[28:31], 0
    v_mfma_f32_32x32x8_bf16 v[84:99], v[42:43], v[26:27], v[84:99]
    s_nop 7
    s_nop 3
    v_max3_f32 v13, v68, v69, v70
    v_max_f32 v13, v13, v71
    v_max3_f32 v13, v13, v72, v73
    v_max3_f32 v13, v13, v74, v75
    v_max3_f32 v13, v13, v76, v77
    v_max3_f32 v13, v13, v78, v79
    v_max3_f32 v13, v13, v80, v81
    v_max3_f32 v13, v13, v82, v83
    v_mov_b32 v14, v13
    s_nop 1
    v_permlane32_swap_b32 v13, v14
    s_nop 1
    v_max_f32 v13, v13, v14
    v_sub_f32 v13, 0, v13
    v_cvt_pk_bf16_f32 v14, v13, v13
    v_lshlrev_b32 v14, 16, v14
    v_sub_f32 v15, v13, v14
    v_cvt_pk_bf16_f32 v16, v15, v15
    v_lshlrev_b32 v16, 16, v16
    v_sub_f32 v15, v15, v16
    s_mov_b32 exec_lo, 0x0
    s_mov_b32 exec_hi, 0xffffffff
    v_cvt_pk_bf16_f32 v24, v14, v16
    v_cvt_pk_bf16_f32 v25, v15, 0
    s_mov_b64 exec, -1
    v_max3_f32 v13, v84, v85, v86
    v_max_f32 v13, v13, v87
    v_max3_f32 v13, v13, v88, v89
    v_max3_f32 v13, v13, v90, v91
    v_max3_f32 v13, v13, v92, v93
    v_max3_f32 v13, v13, v94, v95
    v_max3_f32 v13, v13, v96, v97
    v_max3_f32 v13, v13, v98, v99
    v_mov_b32 v14, v13
    s_nop 1
    v_permlane32_swap_b32 v13, v14
    s_nop 1
    v_max_f32 v13, v13, v14
    v_sub_f32 v13, 0, v13
    v_cvt_pk_bf16_f32 v14, v13, v13
    v_lshlrev_b32 v14, 16, v14
    v_sub_f32 v15, v13, v14
    v_cvt_pk_bf16_f32 v16, v15, v15
    v_lshlrev_b32 v16, 16, v16
    v_sub_f32 v15, v15, v16
    s_mov_b32 exec_lo, 0x0
    s_mov_b32 exec_hi, 0xffffffff
    v_cvt_pk_bf16_f32 v26, v14, v16
    v_cvt_pk_bf16_f32 v27, v15, 0
    s_mov_b64 exec, -1
    v_mov_b32 v64, 0
    v_mov_b32 v56, 0
    v_mov_b32 v65, 0
    v_mov_b32 v57, 0
    v_mov_b32 v66, 0
    v_mov_b32 v58, 0
    v_mov_b32 v67, 0
    v_mov_b32 v59, 0
    s_waitcnt lgkmcnt(0)
    v_mfma_f32_32x32x16_bf16 v[68:83], v[32:35], v[20:23], 0
    v_mfma_f32_32x32x8_bf16 v[68:83], v[36:37], v[24:25], v[68:83]
    s_mov_b32 s41, 0x807f
    s_cmp_ge_u32 s3, 4
    s_cselect_b32 s41, 0x7700, s41
    v_add_u32 v15, s63, v11
    s_mul_i32 s6, s34, 20
    v_lshl_add_u32 v16, v12, 2, s6
    v_lshrrev_b32 v18, 4, v15
    v_mul_u32_u24 v18, 20480, v18
    v_and_b32 v19, 15, v15
    v_lshl_add_u32 v18, v19, 4, v18
    v_lshrrev_b32 v19, 3, v16
    v_lshl_add_u32 v18, v19, 8, v18
    v_bfe_u32 v19, v16, 2, 1
    v_lshl_add_u32 v3, v19, 3, v18
    s_getreg_b32 s52, hwreg(HW_REG_XCC_ID, 0, 4)
    s_lshl_b32 s52, s52, 28
    s_xor_b32 s52, s52, s94
    s_and_b32 s6, s2, 7
    s_lshl_b32 s53, s6, 8
    s_add_u32 s53, s53, 786432
    v_and_b32 v17, 31, v1
    v_lshlrev_b32 v17, 3, v17
    buffer_load_dwordx2 v[18:19], v17, s[64:67], s53 offen sc1
    s_mov_b32 s49, 0
    s_mov_b32 s48, 45056
    s_nop 7
    s_nop 3
sequential_preLN__grouped_kv_mqa__dense_activation_squared_relu__prompt_kernel_loop:
    ds_read_b128 v[38:41], v5 offset:2816
    ds_read_b64 v[42:43], v6 offset:2816
    v_mfma_f32_32x32x16_bf16 v[116:131], v[56:59], v[64:67], v[116:131]
    s_waitcnt lgkmcnt(2)
    s_setprio 2
    v_exp_f32 v68, v68
    v_exp_f32 v69, v69
    v_mfma_f32_32x32x16_bf16 v[84:99], v[32:35], v[28:31], 0
    v_exp_f32 v70, v70
    v_exp_f32 v71, v71
    v_exp_f32 v72, v72
    v_exp_f32 v73, v73
    v_mfma_f32_32x32x8_bf16 v[84:99], v[36:37], v[26:27], v[84:99]
    v_exp_f32 v74, v74
    v_exp_f32 v75, v75
    v_cvt_pk_bf16_f32 v60, v68, v69
    v_cvt_pk_bf16_f32 v61, v70, v71
    v_cvt_pk_bf16_f32 v62, v72, v73
    v_cvt_pk_bf16_f32 v63, v74, v75
    v_exp_f32 v76, v76
    v_exp_f32 v77, v77
    v_mfma_f32_32x32x16_bf16 v[100:115], v[44:47], v[60:63], v[100:115]
    v_exp_f32 v78, v78
    v_exp_f32 v79, v79
    v_exp_f32 v80, v80
    v_exp_f32 v81, v81
    v_exp_f32 v82, v82
    v_exp_f32 v83, v83
    v_cvt_pk_bf16_f32 v64, v76, v77
    v_cvt_pk_bf16_f32 v65, v78, v79
    v_cvt_pk_bf16_f32 v66, v80, v81
    v_cvt_pk_bf16_f32 v67, v82, v83
    ds_read_b128 v[52:55], v7 offset:2816
    ds_read_b128 v[56:59], v7 offset:3584
    v_mfma_f32_32x32x16_bf16 v[100:115], v[48:51], v[64:67], v[100:115]
    s_waitcnt lgkmcnt(2)
    s_setprio 2
    v_exp_f32 v84, v84
    v_exp_f32 v85, v85
    v_mfma_f32_32x32x16_bf16 v[68:83], v[38:41], v[20:23], 0
    v_exp_f32 v86, v86
    v_exp_f32 v87, v87
    v_exp_f32 v88, v88
    v_exp_f32 v89, v89
    v_mfma_f32_32x32x8_bf16 v[68:83], v[42:43], v[24:25], v[68:83]
    v_exp_f32 v90, v90
    v_exp_f32 v91, v91
    v_cvt_pk_bf16_f32 v60, v84, v85
    v_cvt_pk_bf16_f32 v61, v86, v87
    v_cvt_pk_bf16_f32 v62, v88, v89
    v_cvt_pk_bf16_f32 v63, v90, v91
    v_exp_f32 v92, v92
    v_exp_f32 v93, v93
    v_mfma_f32_32x32x16_bf16 v[116:131], v[44:47], v[60:63], v[116:131]
    v_exp_f32 v94, v94
    v_exp_f32 v95, v95
    v_exp_f32 v96, v96
    v_exp_f32 v97, v97
    v_exp_f32 v98, v98
    v_exp_f32 v99, v99
    v_cvt_pk_bf16_f32 v64, v92, v93
    v_cvt_pk_bf16_f32 v65, v94, v95
    v_cvt_pk_bf16_f32 v66, v96, v97
    v_cvt_pk_bf16_f32 v67, v98, v99
    ds_read_b128 v[32:35], v5 offset:5632
    ds_read_b64 v[36:37], v6 offset:5632
    v_mfma_f32_32x32x16_bf16 v[116:131], v[48:51], v[64:67], v[116:131]
    s_waitcnt lgkmcnt(2)
    s_setprio 1
    v_exp_f32 v68, v68
    v_exp_f32 v69, v69
    v_mfma_f32_32x32x16_bf16 v[84:99], v[38:41], v[28:31], 0
    v_exp_f32 v70, v70
    v_exp_f32 v71, v71
    v_exp_f32 v72, v72
    v_exp_f32 v73, v73
    v_mfma_f32_32x32x8_bf16 v[84:99], v[42:43], v[26:27], v[84:99]
    v_exp_f32 v74, v74
    v_exp_f32 v75, v75
    v_cvt_pk_bf16_f32 v60, v68, v69
    v_cvt_pk_bf16_f32 v61, v70, v71
    v_cvt_pk_bf16_f32 v62, v72, v73
    v_cvt_pk_bf16_f32 v63, v74, v75
    v_exp_f32 v76, v76
    v_exp_f32 v77, v77
    v_mfma_f32_32x32x16_bf16 v[100:115], v[52:55], v[60:63], v[100:115]
    v_exp_f32 v78, v78
    v_exp_f32 v79, v79
    v_exp_f32 v80, v80
    v_exp_f32 v81, v81
    v_exp_f32 v82, v82
    v_exp_f32 v83, v83
    v_cvt_pk_bf16_f32 v64, v76, v77
    v_cvt_pk_bf16_f32 v65, v78, v79
    v_cvt_pk_bf16_f32 v66, v80, v81
    v_cvt_pk_bf16_f32 v67, v82, v83
    ds_read_b128 v[44:47], v7 offset:5632
    ds_read_b128 v[48:51], v7 offset:6400
    v_mfma_f32_32x32x16_bf16 v[100:115], v[56:59], v[64:67], v[100:115]
    s_waitcnt lgkmcnt(2)
    s_setprio 1
    v_exp_f32 v84, v84
    v_exp_f32 v85, v85
    v_mfma_f32_32x32x16_bf16 v[68:83], v[32:35], v[20:23], 0
    v_exp_f32 v86, v86
    v_exp_f32 v87, v87
    v_exp_f32 v88, v88
    v_exp_f32 v89, v89
    v_mfma_f32_32x32x8_bf16 v[68:83], v[36:37], v[24:25], v[68:83]
    v_exp_f32 v90, v90
    v_exp_f32 v91, v91
    v_cvt_pk_bf16_f32 v60, v84, v85
    v_cvt_pk_bf16_f32 v61, v86, v87
    v_cvt_pk_bf16_f32 v62, v88, v89
    v_cvt_pk_bf16_f32 v63, v90, v91
    v_exp_f32 v92, v92
    v_exp_f32 v93, v93
    v_mfma_f32_32x32x16_bf16 v[116:131], v[52:55], v[60:63], v[116:131]
    v_exp_f32 v94, v94
    v_exp_f32 v95, v95
    v_exp_f32 v96, v96
    v_exp_f32 v97, v97
    v_exp_f32 v98, v98
    v_exp_f32 v99, v99
    v_cvt_pk_bf16_f32 v64, v92, v93
    v_cvt_pk_bf16_f32 v65, v94, v95
    v_cvt_pk_bf16_f32 v66, v96, v97
    v_cvt_pk_bf16_f32 v67, v98, v99
    s_bitcmp1_b32 s41, s49
    s_cbranch_scc1 sequential_preLN__grouped_kv_mqa__dense_activation_squared_relu__prompt_kernel_tree0
sequential_preLN__grouped_kv_mqa__dense_activation_squared_relu__prompt_kernel_back0:
    ds_read_b128 v[38:41], v5 offset:8448
    ds_read_b64 v[42:43], v6 offset:8448
    v_mfma_f32_32x32x16_bf16 v[116:131], v[56:59], v[64:67], v[116:131]
    s_waitcnt lgkmcnt(2)
    s_setprio 0
    v_exp_f32 v68, v68
    v_exp_f32 v69, v69
    v_mfma_f32_32x32x16_bf16 v[84:99], v[32:35], v[28:31], 0
    v_exp_f32 v70, v70
    v_exp_f32 v71, v71
    v_exp_f32 v72, v72
    v_exp_f32 v73, v73
    v_mfma_f32_32x32x8_bf16 v[84:99], v[36:37], v[26:27], v[84:99]
    v_exp_f32 v74, v74
    v_exp_f32 v75, v75
    v_cvt_pk_bf16_f32 v60, v68, v69
    v_cvt_pk_bf16_f32 v61, v70, v71
    v_cvt_pk_bf16_f32 v62, v72, v73
    v_cvt_pk_bf16_f32 v63, v74, v75
    v_exp_f32 v76, v76
    v_exp_f32 v77, v77
    v_mfma_f32_32x32x16_bf16 v[100:115], v[44:47], v[60:63], v[100:115]
    v_exp_f32 v78, v78
    v_exp_f32 v79, v79
    v_exp_f32 v80, v80
    v_exp_f32 v81, v81
    v_exp_f32 v82, v82
    v_exp_f32 v83, v83
    v_cvt_pk_bf16_f32 v64, v76, v77
    v_cvt_pk_bf16_f32 v65, v78, v79
    v_cvt_pk_bf16_f32 v66, v80, v81
    v_cvt_pk_bf16_f32 v67, v82, v83
    ds_read_b128 v[52:55], v7 offset:8448
    ds_read_b128 v[56:59], v7 offset:9216
    v_mfma_f32_32x32x16_bf16 v[100:115], v[48:51], v[64:67], v[100:115]
    s_waitcnt lgkmcnt(2)
    s_setprio 0
    v_exp_f32 v84, v84
    v_exp_f32 v85, v85
    v_mfma_f32_32x32x16_bf16 v[68:83], v[38:41], v[20:23], 0
    v_exp_f32 v86, v86
    v_exp_f32 v87, v87
    v_exp_f32 v88, v88
    v_exp_f32 v89, v89
    v_mfma_f32_32x32x8_bf16 v[68:83], v[42:43], v[24:25], v[68:83]
    v_exp_f32 v90, v90
    v_exp_f32 v91, v91
    v_cvt_pk_bf16_f32 v60, v84, v85
    v_cvt_pk_bf16_f32 v61, v86, v87
    v_cvt_pk_bf16_f32 v62, v88, v89
    v_cvt_pk_bf16_f32 v63, v90, v91
    v_exp_f32 v92, v92
    v_exp_f32 v93, v93
    v_mfma_f32_32x32x16_bf16 v[116:131], v[44:47], v[60:63], v[116:131]
    v_exp_f32 v94, v94
    v_exp_f32 v95, v95
    v_exp_f32 v96, v96
    v_exp_f32 v97, v97
    v_exp_f32 v98, v98
    v_exp_f32 v99, v99
    v_cvt_pk_bf16_f32 v64, v92, v93
    v_cvt_pk_bf16_f32 v65, v94, v95
    v_cvt_pk_bf16_f32 v66, v96, v97
    v_cvt_pk_bf16_f32 v67, v98, v99
    s_cmp_lg_u32 s54, 0
    s_cbranch_scc1 sequential_preLN__grouped_kv_mqa__dense_activation_squared_relu__prompt_kernel_pend
    s_waitcnt vmcnt(0)
sequential_preLN__grouped_kv_mqa__dense_activation_squared_relu__prompt_kernel_pendx:
    s_mov_b32 s54, 0
    s_barrier
    s_add_u32 s51, s50, 24576
    s_cmp_ge_u32 s51, 159744
    s_cselect_b32 s52, 73728, 0
    s_sub_u32 s51, s51, s52
    v_add_u32 v5, s51, v8
    v_add_u32 v6, s51, v9
    s_cmp_ge_u32 s49, 6
    s_cbranch_scc1 sequential_preLN__grouped_kv_mqa__dense_activation_squared_relu__prompt_kernel_nodma
    s_sub_u32 s52, s51, s97
    s_add_u32 s52, s52, 24576
    s_cmp_ge_u32 s52, 159744
    s_cselect_b32 s52, 86016, s52
    s_add_u32 m0, s7, s52
    s_nop 0
    buffer_load_dwordx4 v4, s[36:39], s48 offen offset:0 sc1 lds
    buffer_load_dwordx4 v4, s[36:39], s48 offen offset:1024 sc1 lds
    buffer_load_dwordx4 v4, s[36:39], s48 offen offset:2048 sc1 lds
    s_add_u32 s48, s48, 22528
sequential_preLN__grouped_kv_mqa__dense_activation_squared_relu__prompt_kernel_nodma:
    s_add_u32 s52, s49, 8
    s_bitcmp1_b32 s41, s52
    s_cbranch_scc1 sequential_preLN__grouped_kv_mqa__dense_activation_squared_relu__prompt_kernel_tree1
sequential_preLN__grouped_kv_mqa__dense_activation_squared_relu__prompt_kernel_back1:
    ds_read_b128 v[32:35], v5 offset:0
    ds_read_b64 v[36:37], v6 offset:0
    v_mfma_f32_32x32x16_bf16 v[116:131], v[48:51], v[64:67], v[116:131]
    s_waitcnt lgkmcnt(2)
    s_setprio 3
    v_exp_f32 v68, v68
    v_exp_f32 v69, v69
    v_mfma_f32_32x32x16_bf16 v[84:99], v[38:41], v[28:31], 0
    v_exp_f32 v70, v70
    v_exp_f32 v71, v71
    v_exp_f32 v72, v72
    v_exp_f32 v73, v73
    v_mfma_f32_32x32x8_bf16 v[84:99], v[42:43], v[26:27], v[84:99]
    v_exp_f32 v74, v74
    v_exp_f32 v75, v75
    v_cvt_pk_bf16_f32 v60, v68, v69
    v_cvt_pk_bf16_f32 v61, v70, v71
    v_cvt_pk_bf16_f32 v62, v72, v73
    v_cvt_pk_bf16_f32 v63, v74, v75
    v_exp_f32 v76, v76
    v_exp_f32 v77, v77
    v_mfma_f32_32x32x16_bf16 v[100:115], v[52:55], v[60:63], v[100:115]
    v_exp_f32 v78, v78
    v_exp_f32 v79, v79
    v_exp_f32 v80, v80
    v_exp_f32 v81, v81
    v_exp_f32 v82, v82
    v_exp_f32 v83, v83
    v_cvt_pk_bf16_f32 v64, v76, v77
    v_cvt_pk_bf16_f32 v65, v78, v79
    v_cvt_pk_bf16_f32 v66, v80, v81
    v_cvt_pk_bf16_f32 v67, v82, v83
    v_add_u32 v7, s51, v10
    s_mov_b32 s50, s51
    ds_read_b128 v[44:47], v7 offset:0
    ds_read_b128 v[48:51], v7 offset:768
    v_mfma_f32_32x32x16_bf16 v[100:115], v[56:59], v[64:67], v[100:115]
    s_waitcnt lgkmcnt(2)
    s_setprio 3
    v_exp_f32 v84, v84
    v_exp_f32 v85, v85
    v_mfma_f32_32x32x16_bf16 v[68:83], v[32:35], v[20:23], 0
    v_exp_f32 v86, v86
    v_exp_f32 v87, v87
    v_exp_f32 v88, v88
    v_exp_f32 v89, v89
    v_mfma_f32_32x32x8_bf16 v[68:83], v[36:37], v[24:25], v[68:83]
    v_exp_f32 v90, v90
    v_exp_f32 v91, v91
    v_cvt_pk_bf16_f32 v60, v84, v85
    v_cvt_pk_bf16_f32 v61, v86, v87
    v_cvt_pk_bf16_f32 v62, v88, v89
    v_cvt_pk_bf16_f32 v63, v90, v91
    v_exp_f32 v92, v92
    v_exp_f32 v93, v93
    v_mfma_f32_32x32x16_bf16 v[116:131], v[52:55], v[60:63], v[116:131]
    v_exp_f32 v94, v94
    v_exp_f32 v95, v95
    v_exp_f32 v96, v96
    v_exp_f32 v97, v97
    v_exp_f32 v98, v98
    v_exp_f32 v99, v99
    v_cvt_pk_bf16_f32 v64, v92, v93
    v_cvt_pk_bf16_f32 v65, v94, v95
    v_cvt_pk_bf16_f32 v66, v96, v97
    v_cvt_pk_bf16_f32 v67, v98, v99
    s_add_u32 s49, s49, 1
    s_cmp_lt_u32 s49, 8
    s_cbranch_scc1 sequential_preLN__grouped_kv_mqa__dense_activation_squared_relu__prompt_kernel_loop
    v_mfma_f32_32x32x16_bf16 v[116:131], v[56:59], v[64:67], v[116:131]
    s_setprio 0
    s_lshl_b32 s40, s63, 7
    s_lshl_b32 s6, s34, 3
    s_add_u32 s40, s40, s6
    s_mul_i32 s6, s3, 3072
    s_add_u32 s6, s6, 135168
    v_add_u32 v13, s6, v8
    s_xor_b32 s6, s3, 1
    s_mul_i32 s6, s6, 3072
    s_add_u32 s6, s6, 135168
    v_add_u32 v14, s6, v8
    s_nop 7
    ds_write_b128 v13, v[116:119] offset:0
    ds_write_b128 v13, v[120:123] offset:1024
    ds_write_b128 v13, v[124:127] offset:2048
    s_waitcnt lgkmcnt(0)
    s_barrier
    ds_read_b128 v[68:71], v14 offset:0
    ds_read_b128 v[72:75], v14 offset:1024
    ds_read_b128 v[76:79], v14 offset:2048
    s_waitcnt lgkmcnt(0)
    v_add_f32 v100, v100, v68
    v_add_f32 v101, v101, v69
    v_add_f32 v102, v102, v70
    v_add_f32 v103, v103, v71
    v_add_f32 v104, v104, v72
    v_add_f32 v105, v105, v73
    v_add_f32 v106, v106, v74
    v_add_f32 v107, v107, v75
    v_add_f32 v108, v108, v76
    v_add_f32 v109, v109, v77
    v_add_f32 v110, v110, v78
    v_add_f32 v111, v111, v79
    s_mov_b32 s53, 0
sequential_preLN__grouped_kv_mqa__dense_activation_squared_relu__prompt_kernel_fin:
    v_mov_b32 v13, v108
    v_mov_b32 v14, v108
    s_nop 1
    v_permlane32_swap_b32 v13, v14
    s_cmp_lg_u32 s53, 0
    s_cbranch_scc1 sequential_preLN__grouped_kv_mqa__dense_activation_squared_relu__prompt_kernel_store
    v_add_f32 v15, abs(v100), abs(v101)
    v_add_f32 v15, v15, abs(v102)
    v_add_f32 v15, v15, abs(v103)
    v_add_f32 v15, v15, abs(v104)
    v_add_f32 v15, v15, abs(v105)
    v_add_f32 v15, v15, abs(v106)
    v_add_f32 v15, v15, abs(v107)
    v_add_f32 v15, v15, abs(v108)
    v_add_f32 v15, v15, abs(v109)
    v_add_f32 v15, v15, abs(v110)
    v_add_f32 v15, v15, abs(v111)
    v_mov_b32 v16, 0x7f000000
    v_cmp_lt_f32 s[48:49], v15, v16
    v_mov_b32 v16, 0x1f800000
    v_cmp_ge_f32 s[50:51], v14, v16
    v_mov_b32 v16, 0x5f800000
    v_cmp_le_f32 vcc, v14, v16
    s_and_b64 s[48:49], s[48:49], s[50:51]
    s_and_b64 s[48:49], s[48:49], vcc
    s_cmp_eq_u64 s[48:49], -1
    s_cbranch_scc0 sequential_preLN__grouped_kv_mqa__dense_activation_squared_relu__prompt_kernel_slow
sequential_preLN__grouped_kv_mqa__dense_activation_squared_relu__prompt_kernel_store:
    v_rcp_f32 v14, v14
    s_nop 0
    s_cmp_lg_u32 s55, 1
    s_cbranch_scc1 sequential_preLN__grouped_kv_mqa__dense_activation_squared_relu__prompt_kernel_sc_13
    v_mul_f32 v100, v100, v14
    v_mul_f32 v101, v101, v14
    v_mul_f32 v102, v102, v14
    v_mul_f32 v103, v103, v14
    v_cvt_pk_bf16_f32 v100, v100, v101
    v_cvt_pk_bf16_f32 v101, v102, v103
    buffer_store_dwordx2 v[100:101], v3, s[44:47], 0 offen offset:0
    v_mul_f32 v104, v104, v14
    v_mul_f32 v105, v105, v14
    v_mul_f32 v106, v106, v14
    v_mul_f32 v107, v107, v14
    v_cvt_pk_bf16_f32 v104, v104, v105
    v_cvt_pk_bf16_f32 v105, v106, v107
    buffer_store_dwordx2 v[104:105], v3, s[44:47], 0 offen offset:256
    v_mul_f32 v108, v108, v14
    v_mul_f32 v109, v109, v14
    v_mul_f32 v110, v110, v14
    v_mul_f32 v111, v111, v14
    v_cvt_pk_bf16_f32 v108, v108, v109
    v_cvt_pk_bf16_f32 v109, v110, v111
    s_mov_b32 exec_lo, 0xffffffff
    s_mov_b32 exec_hi, 0x0
    buffer_store_dwordx2 v[108:109], v3, s[44:47], 0 offen offset:512
    s_mov_b64 exec, -1
    v_lshlrev_b32 v13, 8, v1
    v_mov_b32 v14, s94
    v_mov_b32 v15, s95
    s_waitcnt vmcnt(0)
    s_mov_b32 exec_lo, 0xffff
    s_mov_b32 exec_hi, 0x0
    buffer_store_dwordx2 v[14:15], v13, s[64:67], s40 offen
    s_mov_b64 exec, -1
sequential_preLN__grouped_kv_mqa__dense_activation_squared_relu__prompt_kernel_sc_14:
    s_cmp_ge_u32 s3, 4
    s_cbranch_scc1 sequential_preLN__grouped_kv_mqa__dense_activation_squared_relu__prompt_kernel_loader
    s_setprio 3
    v_lshlrev_b32 v4, 4, v1
    v_add_u32 v5, 49152, v4
    v_add_u32 v6, 98304, v4
    s_and_b32 s52, s3, 1
    s_lshl_b32 s52, s52, 1
    s_lshr_b32 s34, s3, 1
    s_add_u32 s52, s52, s34
    s_lshl_b32 s62, s4, 2
    s_add_u32 s62, s62, s52
    s_mul_i32 s6, s34, 5120
    v_add_u32 v72, s6, v4
    v_add_u32 v73, s6, v5
    v_add_u32 v74, s6, v6
    s_mul_i32 s6, s62, 20480
    s_lshl_b32 s52, s34, 10
    s_add_u32 s6, s6, s52
    v_add_u32 v7, s6, v4
    s_xor_b32 s6, s62, 1
    s_mul_i32 s6, s6, 20480
    s_add_u32 s6, s6, s52
    v_add_u32 v75, s6, v4
    s_lshl_b32 s6, s3, 10
    s_add_u32 s6, s6, 147456
    v_add_u32 v76, s6, v4
    s_lshr_b32 s6, s3, 1
    s_mul_i32 s6, s6, 10240
    s_sub_u32 s6, s6, 38912
    v_add_u32 v77, s6, v76
    s_xor_b32 s52, s3, 2
    s_lshl_b32 s6, s52, 10
    s_add_u32 s6, s6, 147456
    v_add_u32 v78, s6, v4
    s_lshr_b32 s6, s52, 1
    s_mul_i32 s6, s6, 10240
    s_sub_u32 s6, s6, 38912
    v_add_u32 v79, s6, v78
    s_lshl_b32 s6, s62, 4
    v_and_b32 v8, 15, v1
    v_add_u32 v8, s6, v8
    v_lshrrev_b32 v9, 4, v1
    s_mul_i32 s6, s5, 80
    v_lshl_add_u32 v10, v9, 2, s6
    v_mul_u32_u24 v11, 1280, v8
    v_lshl_add_u32 v11, v10, 1, v11
    v_lshrrev_b32 v16, 4, v8
    v_mul_u32_u24 v16, 20480, v16
    v_and_b32 v17, 15, v8
    v_lshl_add_u32 v16, v17, 4, v16
    v_lshrrev_b32 v17, 3, v10
    v_lshl_add_u32 v16, v17, 8, v16
    v_bfe_u32 v17, v10, 2, 1
    v_lshl_add_u32 v12, v17, 3, v16
    s_add_u32 s40, s32, 0x600000
    s_addc_u32 s41, s33, 0
    s_mov_b32 s42, 0x280000
    s_mov_b32 s43, 0x00020000
    s_add_u32 s48, s32, 0x900000
    s_addc_u32 s49, s33, 0
    s_mov_b32 s50, 0x20000
    s_mov_b32 s51, 0x00020000
    s_lshr_b32 s52, s62, 1
    s_lshl_b32 s52, s52, 4
    s_lshl_b32 s6, s5, 1
    s_add_u32 s52, s52, s6
    s_and_b32 s6, s62, 1
    s_add_u32 s52, s52, s6
    s_lshl_b32 s52, s52, 8
    s_barrier
    ds_read_b128 v[24:27], v72 offset:0
    ds_read_b128 v[28:31], v72 offset:1024
    ds_read_b128 v[32:35], v72 offset:2048
    ds_read_b128 v[36:39], v72 offset:3072
    ds_read_b128 v[40:43], v72 offset:4096
    v_and_b32 v16, 31, v1
    v_lshlrev_b32 v16, 3, v16
    s_mov_b32 s53, 262144
L_pg_15:
    buffer_load_dwordx2 v[18:19], v16, s[64:67], s52 offen sc1
    s_sub_u32 s53, s53, 1
    s_cmp_eq_u32 s53, 0
    s_cbranch_scc1 L_pg_15_x
    s_waitcnt vmcnt(0)
    v_cmp_ne_u64 vcc, s[94:95], v[18:19]
    s_cbranch_vccnz L_pg_15
L_pg_15_x:
    buffer_load_dwordx4 v[120:123], v7, s[44:47], 0 offen offset:0 sc1
    buffer_load_dwordx4 v[124:127], v75, s[44:47], 0 offen offset:0 sc1
    buffer_load_dwordx4 v[128:131], v7, s[44:47], 0 offen offset:2048 sc1
    buffer_load_dwordx4 v[132:135], v75, s[44:47], 0 offen offset:2048 sc1
    s_mov_b32 s6, 4096
    buffer_load_dwordx4 v[136:139], v7, s[44:47], s6 offen offset:0 sc1
    buffer_load_dwordx4 v[140:143], v75, s[44:47], s6 offen offset:0 sc1
    s_mov_b32 s6, 4096
    buffer_load_dwordx4 v[144:147], v7, s[44:47], s6 offen offset:2048 sc1
    buffer_load_dwordx4 v[148:151], v75, s[44:47], s6 offen offset:2048 sc1
    s_waitcnt vmcnt(6) lgkmcnt(0)
    ds_read_b128 v[48:51], v72 offset:12288
    v_mfma_f32_16x16x32_bf16 v[200:203], v[24:27], v[120:123], v[200:203]
    ds_read_b128 v[52:55], v72 offset:13312
    v_mfma_f32_16x16x32_bf16 v[220:223], v[24:27], v[124:127], 0
    ds_read_b128 v[56:59], v72 offset:14336
    v_mfma_f32_16x16x32_bf16 v[204:207], v[28:31], v[120:123], v[204:207]
    ds_read_b128 v[60:63], v72 offset:15360
    v_mfma_f32_16x16x32_bf16 v[224:227], v[28:31], v[124:127], 0
    ds_read_b128 v[64:67], v72 offset:16384
    v_mfma_f32_16x16x32_bf16 v[208:211], v[32:35], v[120:123], v[208:211]
    v_mfma_f32_16x16x32_bf16 v[228:231], v[32:35], v[124:127], 0
    v_mfma_f32_16x16x32_bf16 v[212:215], v[36:39], v[120:123], v[212:215]
    v_mfma_f32_16x16x32_bf16 v[232:235], v[36:39], v[124:127], 0
    v_mfma_f32_16x16x32_bf16 v[216:219], v[40:43], v[120:123], v[216:219]
    v_mfma_f32_16x16x32_bf16 v[236:239], v[40:43], v[124:127], 0
    s_mov_b32 s6, 8192
    buffer_load_dwordx4 v[152:155], v7, s[44:47], s6 offen offset:0 sc1
    buffer_load_dwordx4 v[156:159], v75, s[44:47], s6 offen offset:0 sc1
    s_mov_b32 s6, 8192
    buffer_load_dwordx4 v[160:163], v7, s[44:47], s6 offen offset:2048 sc1
    buffer_load_dwordx4 v[164:167], v75, s[44:47], s6 offen offset:2048 sc1
    s_mov_b32 s6, 12288
    buffer_load_dwordx4 v[168:171], v7, s[44:47], s6 offen offset:0 sc1
    buffer_load_dwordx4 v[172:175], v75, s[44:47], s6 offen offset:0 sc1
    s_waitcnt vmcnt(10) lgkmcnt(0)
    ds_read_b128 v[24:27], v72 offset:24576
    v_mfma_f32_16x16x32_bf16 v[200:203], v[48:51], v[128:131], v[200:203]
    ds_read_b128 v[28:31], v72 offset:25600
    v_mfma_f32_16x16x32_bf16 v[220:223], v[48:51], v[132:135], v[220:223]
    ds_read_b128 v[32:35], v72 offset:26624
    v_mfma_f32_16x16x32_bf16 v[204:207], v[52:55], v[128:131], v[204:207]
    ds_read_b128 v[36:39], v72 offset:27648
    v_mfma_f32_16x16x32_bf16 v[224:227], v[52:55], v[132:135], v[224:227]
    ds_read_b128 v[40:43], v72 offset:28672
    v_mfma_f32_16x16x32_bf16 v[208:211], v[56:59], v[128:131], v[208:211]
    v_mfma_f32_16x16x32_bf16 v[228:231], v[56:59], v[132:135], v[228:231]
    v_mfma_f32_16x16x32_bf16 v[212:215], v[60:63], v[128:131], v[212:215]
    v_mfma_f32_16x16x32_bf16 v[232:235], v[60:63], v[132:135], v[232:235]
    v_mfma_f32_16x16x32_bf16 v[216:219], v[64:67], v[128:131], v[216:219]
    v_mfma_f32_16x16x32_bf16 v[236:239], v[64:67], v[132:135], v[236:239]
    s_mov_b32 s6, 12288
    buffer_load_dwordx4 v[176:179], v7, s[44:47], s6 offen offset:2048 sc1
    buffer_load_dwordx4 v[180:183], v75, s[44:47], s6 offen offset:2048 sc1
    s_mov_b32 s6, 16384
    buffer_load_dwordx4 v[184:187], v7, s[44:47], s6 offen offset:0 sc1
    buffer_load_dwordx4 v[188:191], v75, s[44:47], s6 offen offset:0 sc1
    s_mov_b32 s6, 16384
    buffer_load_dwordx4 v[192:195], v7, s[44:47], s6 offen offset:2048 sc1
    buffer_load_dwordx4 v[196:199], v75, s[44:47], s6 offen offset:2048 sc1
    s_waitcnt vmcnt(14) lgkmcnt(0)
    ds_read_b128 v[48:51], v72 offset:36864
    v_mfma_f32_16x16x32_bf16 v[200:203], v[24:27], v[136:139], v[200:203]
    ds_read_b128 v[52:55], v72 offset:37888
    v_mfma_f32_16x16x32_bf16 v[220:223], v[24:27], v[140:143], v[220:223]
    ds_read_b128 v[56:59], v72 offset:38912
    v_mfma_f32_16x16x32_bf16 v[204:207], v[28:31], v[136:139], v[204:207]
    ds_read_b128 v[60:63], v72 offset:39936
    v_mfma_f32_16x16x32_bf16 v[224:227], v[28:31], v[140:143], v[224:227]
    ds_read_b128 v[64:67], v72 offset:40960
    v_mfma_f32_16x16x32_bf16 v[208:211], v[32:35], v[136:139], v[208:211]
    v_mfma_f32_16x16x32_bf16 v[228:231], v[32:35], v[140:143], v[228:231]
    v_mfma_f32_16x16x32_bf16 v[212:215], v[36:39], v[136:139], v[212:215]
    v_mfma_f32_16x16x32_bf16 v[232:235], v[36:39], v[140:143], v[232:235]
    v_mfma_f32_16x16x32_bf16 v[216:219], v[40:43], v[136:139], v[216:219]
    v_mfma_f32_16x16x32_bf16 v[236:239], v[40:43], v[140:143], v[236:239]
    s_waitcnt vmcnt(12) lgkmcnt(0)
    ds_read_b128 v[24:27], v73 offset:0
    v_mfma_f32_16x16x32_bf16 v[200:203], v[48:51], v[144:147], v[200:203]
    ds_read_b128 v[28:31], v73 offset:1024
    v_mfma_f32_16x16x32_bf16 v[220:223], v[48:51], v[148:151], v[220:223]
    ds_read_b128 v[32:35], v73 offset:2048
    v_mfma_f32_16x16x32_bf16 v[204:207], v[52:55], v[144:147], v[204:207]
    ds_read_b128 v[36:39], v73 offset:3072
    v_mfma_f32_16x16x32_bf16 v[224:227], v[52:55], v[148:151], v[224:227]
    ds_read_b128 v[40:43], v73 offset:4096
    v_mfma_f32_16x16x32_bf16 v[208:211], v[56:59], v[144:147], v[208:211]
    v_mfma_f32_16x16x32_bf16 v[228:231], v[56:59], v[148:151], v[228:231]
    v_mfma_f32_16x16x32_bf16 v[212:215], v[60:63], v[144:147], v[212:215]
    v_mfma_f32_16x16x32_bf16 v[232:235], v[60:63], v[148:151], v[232:235]
    v_mfma_f32_16x16x32_bf16 v[216:219], v[64:67], v[144:147], v[216:219]
    v_mfma_f32_16x16x32_bf16 v[236:239], v[64:67], v[148:151], v[236:239]
    s_barrier
    s_waitcnt vmcnt(10) lgkmcnt(0)
    ds_read_b128 v[48:51], v73 offset:12288
    v_mfma_f32_16x16x32_bf16 v[200:203], v[24:27], v[152:155], v[200:203]
    ds_read_b128 v[52:55], v73 offset:13312
    v_mfma_f32_16x16x32_bf16 v[220:223], v[24:27], v[156:159], v[220:223]
    ds_read_b128 v[56:59], v73 offset:14336
    v_mfma_f32_16x16x32_bf16 v[204:207], v[28:31], v[152:155], v[204:207]
    ds_read_b128 v[60:63], v73 offset:15360
    v_mfma_f32_16x16x32_bf16 v[224:227], v[28:31], v[156:159], v[224:227]
    ds_read_b128 v[64:67], v73 offset:16384
    v_mfma_f32_16x16x32_bf16 v[208:211], v[32:35], v[152:155], v[208:211]
    v_mfma_f32_16x16x32_bf16 v[228:231], v[32:35], v[156:159], v[228:231]
    v_mfma_f32_16x16x32_bf16 v[212:215], v[36:39], v[152:155], v[212:215]
    v_mfma_f32_16x16x32_bf16 v[232:235], v[36:39], v[156:159], v[232:235]
    v_mfma_f32_16x16x32_bf16 v[216:219], v[40:43], v[152:155], v[216:219]
    v_mfma_f32_16x16x32_bf16 v[236:239], v[40:43], v[156:159], v[236:239]
    s_waitcnt vmcnt(8) lgkmcnt(0)
    ds_read_b128 v[24:27], v73 offset:24576
    v_mfma_f32_16x16x32_bf16 v[200:203], v[48:51], v[160:163], v[200:203]
    ds_read_b128 v[28:31], v73 offset:25600
    v_mfma_f32_16x16x32_bf16 v[220:223], v[48:51], v[164:167], v[220:223]
    ds_read_b128 v[32:35], v73 offset:26624
    v_mfma_f32_16x16x32_bf16 v[204:207], v[52:55], v[160:163], v[204:207]
    ds_read_b128 v[36:39], v73 offset:27648
    v_mfma_f32_16x16x32_bf16 v[224:227], v[52:55], v[164:167], v[224:227]
    ds_read_b128 v[40:43], v73 offset:28672
    v_mfma_f32_16x16x32_bf16 v[208:211], v[56:59], v[160:163], v[208:211]
    v_mfma_f32_16x16x32_bf16 v[228:231], v[56:59], v[164:167], v[228:231]
    v_mfma_f32_16x16x32_bf16 v[212:215], v[60:63], v[160:163], v[212:215]
    v_mfma_f32_16x16x32_bf16 v[232:235], v[60:63], v[164:167], v[232:235]
    v_mfma_f32_16x16x32_bf16 v[216:219], v[64:67], v[160:163], v[216:219]
    v_mfma_f32_16x16x32_bf16 v[236:239], v[64:67], v[164:167], v[236:239]
    s_waitcnt vmcnt(6) lgkmcnt(0)
    ds_read_b128 v[48:51], v73 offset:36864
    v_mfma_f32_16x16x32_bf16 v[200:203], v[24:27], v[168:171], v[200:203]
    ds_read_b128 v[52:55], v73 offset:37888
    v_mfma_f32_16x16x32_bf16 v[220:223], v[24:27], v[172:175], v[220:223]
    ds_read_b128 v[56:59], v73 offset:38912
    v_mfma_f32_16x16x32_bf16 v[204:207], v[28:31], v[168:171], v[204:207]
    ds_read_b128 v[60:63], v73 offset:39936
    v_mfma_f32_16x16x32_bf16 v[224:227], v[28:31], v[172:175], v[224:227]
    ds_read_b128 v[64:67], v73 offset:40960
    v_mfma_f32_16x16x32_bf16 v[208:211], v[32:35], v[168:171], v[208:211]
    v_mfma_f32_16x16x32_bf16 v[228:231], v[32:35], v[172:175], v[228:231]
    v_mfma_f32_16x16x32_bf16 v[212:215], v[36:39], v[168:171], v[212:215]
    v_mfma_f32_16x16x32_bf16 v[232:235], v[36:39], v[172:175], v[232:235]
    v_mfma_f32_16x16x32_bf16 v[216:219], v[40:43], v[168:171], v[216:219]
    v_mfma_f32_16x16x32_bf16 v[236:239], v[40:43], v[172:175], v[236:239]
    s_waitcnt vmcnt(4) lgkmcnt(0)
    ds_read_b128 v[24:27], v74 offset:0
    v_mfma_f32_16x16x32_bf16 v[200:203], v[48:51], v[176:179], v[200:203]
    ds_read_b128 v[28:31], v74 offset:1024
    v_mfma_f32_16x16x32_bf16 v[220:223], v[48:51], v[180:183], v[220:223]
    ds_read_b128 v[32:35], v74 offset:2048
    v_mfma_f32_16x16x32_bf16 v[204:207], v[52:55], v[176:179], v[204:207]
    ds_read_b128 v[36:39], v74 offset:3072
    v_mfma_f32_16x16x32_bf16 v[224:227], v[52:55], v[180:183], v[224:227]
    ds_read_b128 v[40:43], v74 offset:4096
    v_mfma_f32_16x16x32_bf16 v[208:211], v[56:59], v[176:179], v[208:211]
    v_mfma_f32_16x16x32_bf16 v[228:231], v[56:59], v[180:183], v[228:231]
    v_mfma_f32_16x16x32_bf16 v[212:215], v[60:63], v[176:179], v[212:215]
    v_mfma_f32_16x16x32_bf16 v[232:235], v[60:63], v[180:183], v[232:235]
    v_mfma_f32_16x16x32_bf16 v[216:219], v[64:67], v[176:179], v[216:219]
    v_mfma_f32_16x16x32_bf16 v[236:239], v[64:67], v[180:183], v[236:239]
    s_barrier
    s_waitcnt vmcnt(2) lgkmcnt(0)
    ds_read_b128 v[48:51], v74 offset:12288
    v_mfma_f32_16x16x32_bf16 v[200:203], v[24:27], v[184:187], v[200:203]
    ds_read_b128 v[52:55], v74 offset:13312
    v_mfma_f32_16x16x32_bf16 v[220:223], v[24:27], v[188:191], v[220:223]
    ds_read_b128 v[56:59], v74 offset:14336
    v_mfma_f32_16x16x32_bf16 v[204:207], v[28:31], v[184:187], v[204:207]
    ds_read_b128 v[60:63], v74 offset:15360
    v_mfma_f32_16x16x32_bf16 v[224:227], v[28:31], v[188:191], v[224:227]
    ds_read_b128 v[64:67], v74 offset:16384
    v_mfma_f32_16x16x32_bf16 v[208:211], v[32:35], v[184:187], v[208:211]
    v_mfma_f32_16x16x32_bf16 v[228:231], v[32:35], v[188:191], v[228:231]
    v_mfma_f32_16x16x32_bf16 v[212:215], v[36:39], v[184:187], v[212:215]
    v_mfma_f32_16x16x32_bf16 v[232:235], v[36:39], v[188:191], v[232:235]
    v_mfma_f32_16x16x32_bf16 v[216:219], v[40:43], v[184:187], v[216:219]
    v_mfma_f32_16x16x32_bf16 v[236:239], v[40:43], v[188:191], v[236:239]
    s_waitcnt vmcnt(0) lgkmcnt(0)
    v_mfma_f32_16x16x32_bf16 v[200:203], v[48:51], v[192:195], v[200:203]
    v_mfma_f32_16x16x32_bf16 v[220:223], v[48:51], v[196:199], v[220:223]
    v_mfma_f32_16x16x32_bf16 v[204:207], v[52:55], v[192:195], v[204:207]
    v_mfma_f32_16x16x32_bf16 v[224:227], v[52:55], v[196:199], v[224:227]
    v_mfma_f32_16x16x32_bf16 v[208:211], v[56:59], v[192:195], v[208:211]
    v_mfma_f32_16x16x32_bf16 v[228:231], v[56:59], v[196:199], v[228:231]
    v_mfma_f32_16x16x32_bf16 v[212:215], v[60:63], v[192:195], v[212:215]
    v_mfma_f32_16x16x32_bf16 v[232:235], v[60:63], v[196:199], v[232:235]
    v_mfma_f32_16x16x32_bf16 v[216:219], v[64:67], v[192:195], v[216:219]
    v_mfma_f32_16x16x32_bf16 v[236:239], v[64:67], v[196:199], v[236:239]
    s_nop 7
    ds_write_b128 v76, v[220:223] offset:0
    ds_write_b128 v76, v[224:227] offset:4096
    ds_write_b128 v76, v[228:231] offset:8192
    ds_write_b128 v76, v[232:235] offset:12288
    ds_write_b128 v77, v[236:239] offset:0
    s_waitcnt lgkmcnt(0)
    s_barrier
    ds_read_b128 v[24:27], v78 offset:0
    ds_read_b128 v[28:31], v78 offset:4096
    ds_read_b128 v[32:35], v78 offset:8192
    ds_read_b128 v[36:39], v78 offset:12288
    ds_read_b128 v[40:43], v79 offset:0
    s_waitcnt lgkmcnt(4)
    v_pk_add_f32 v[200:201], v[200:201], v[24:25]
    v_pk_add_f32 v[202:203], v[202:203], v[26:27]
    s_waitcnt lgkmcnt(3)
    v_pk_add_f32 v[204:205], v[204:205], v[28:29]
    v_pk_add_f32 v[206:207], v[206:207], v[30:31]
    s_waitcnt lgkmcnt(2)
    v_pk_add_f32 v[208:209], v[208:209], v[32:33]
    v_pk_add_f32 v[210:211], v[210:211], v[34:35]
    s_waitcnt lgkmcnt(1)
    v_pk_add_f32 v[212:213], v[212:213], v[36:37]
    v_pk_add_f32 v[214:215], v[214:215], v[38:39]
    s_waitcnt lgkmcnt(0)
    v_pk_add_f32 v[216:217], v[216:217], v[40:41]
    v_pk_add_f32 v[218:219], v[218:219], v[42:43]
    v_mov_b32 v14, 0
    v_mov_b32 v15, 0
    v_mov_b32 v20, 0x3f803f80
    s_lshl_b32 s6, s5, 3
    v_lshl_add_u32 v13, v8, 6, s6
    v_cvt_pk_bf16_f32 v248, v200, v201
    v_cvt_pk_bf16_f32 v249, v202, v203
    v_cvt_pk_bf16_f32 v250, v204, v205
    v_cvt_pk_bf16_f32 v251, v206, v207
    v_cvt_pk_bf16_f32 v252, v208, v209
    v_cvt_pk_bf16_f32 v253, v210, v211
    v_cvt_pk_bf16_f32 v254, v212, v213
    v_cvt_pk_bf16_f32 v255, v214, v215
    v_cvt_pk_bf16_f32 v2, v216, v217
    v_cvt_pk_bf16_f32 v3, v218, v219
    s_cmp_lg_u32 s55, 1
    s_cbranch_scc1 sequential_preLN__grouped_kv_mqa__dense_activation_squared_relu__prompt_kernel_sc_16
    buffer_store_dwordx2 v[248:249], v12, s[40:43], 0 offen offset:0
    buffer_store_dwordx2 v[250:251], v12, s[40:43], 0 offen offset:512
    buffer_store_dwordx2 v[252:253], v12, s[40:43], 0 offen offset:1024
    buffer_store_dwordx2 v[254:255], v12, s[40:43], 0 offen offset:1536
    buffer_store_dwordx2 v[2:3], v12, s[40:43], 0 offen offset:2048
sequential_preLN__grouped_kv_mqa__dense_activation_squared_relu__prompt_kernel_sc_17:
    v_dot2_f32_bf16 v14, v248, v20, v14
    v_dot2_f32_bf16 v15, v248, v248, v15
    v_dot2_f32_bf16 v14, v249, v20, v14
    v_dot2_f32_bf16 v15, v249, v249, v15
    v_dot2_f32_bf16 v14, v250, v20, v14
    v_dot2_f32_bf16 v15, v250, v250, v15
    v_dot2_f32_bf16 v14, v251, v20, v14
    v_dot2_f32_bf16 v15, v251, v251, v15
    v_dot2_f32_bf16 v14, v252, v20, v14
    v_dot2_f32_bf16 v15, v252, v252, v15
    v_dot2_f32_bf16 v14, v253, v20, v14
    v_dot2_f32_bf16 v15, v253, v253, v15
    v_dot2_f32_bf16 v14, v254, v20, v14
    v_dot2_f32_bf16 v15, v254, v254, v15
    v_dot2_f32_bf16 v14, v255, v20, v14
    v_dot2_f32_bf16 v15, v255, v255, v15
    v_dot2_f32_bf16 v14, v2, v20, v14
    v_dot2_f32_bf16 v15, v2, v2, v15
    v_dot2_f32_bf16 v14, v3, v20, v14
    v_dot2_f32_bf16 v15, v3, v3, v15
    s_lshr_b32 s63, s62, 1
    s_lshl_b32 s63, s63, 12
    s_and_b32 s6, s62, 1
    s_lshl_b32 s6, s6, 3
    s_add_u32 s6, s6, s5
    s_lshl_b32 s6, s6, 3
    s_add_u32 s63, s63, s6
    s_add_u32 s63, s63, 262144
    v_mov_b32 v16, v14
    v_mov_b32 v17, v15
    s_nop 1
    v_permlane16_swap_b32 v14, v16
    v_permlane16_swap_b32 v15, v17
    s_nop 1
    v_add_f32 v14, v14, v16
    v_add_f32 v15, v15, v17
    v_mov_b32 v16, v14
    v_mov_b32 v17, v15
    s_nop 1
    v_permlane32_swap_b32 v14, v16
    v_permlane32_swap_b32 v15, v17
    s_nop 1
    v_add_f32 v14, v14, v16
    v_add_f32 v15, v15, v17
    s_cmp_lg_u32 s55, 1
    s_cbranch_scc1 sequential_preLN__grouped_kv_mqa__dense_activation_squared_relu__prompt_kernel_sc_18
    buffer_store_dwordx2 v[14:15], v13, s[48:51], 0 offen
    v_lshlrev_b32 v16, 8, v1
    v_mov_b32 v18, s94
    v_mov_b32 v19, s95
    s_waitcnt vmcnt(0)
    s_mov_b32 exec_lo, 0xffff
    s_mov_b32 exec_hi, 0x0
    buffer_store_dwordx2 v[18:19], v16, s[64:67], s63 offen
    s_mov_b64 exec, -1
sequential_preLN__grouped_kv_mqa__dense_activation_squared_relu__prompt_kernel_sc_19:
    s_lshl_b32 s35, s60, 3
    s_lshl_b32 s6, s3, 1
    s_add_u32 s35, s35, s6
    s_mul_i32 s6, s35, 20480
    v_add_u32 v7, s6, v4
    s_lshl_b32 s6, s35, 4
    v_and_b32 v22, 15, v1
    v_add_u32 v22, s6, v22
    s_mul_i32 s6, s61, 96
    v_lshl_add_u32 v23, v9, 2, s6
    v_lshlrev_b32 v13, 6, v22
    v_lshl_add_u32 v13, v9, 4, v13
    v_lshrrev_b32 v16, 4, v22
    v_mul_u32_u24 v16, 49152, v16
    v_and_b32 v17, 15, v22
    v_lshl_add_u32 v16, v17, 4, v16
    v_lshrrev_b32 v17, 3, v23
    v_lshl_add_u32 v16, v17, 8, v16
    v_bfe_u32 v17, v23, 2, 1
    v_lshl_add_u32 v12, v17, 3, v16
    s_mul_i32 s6, s61, 3072
    s_add_u32 s6, s6, 4751360
    v_lshlrev_b32 v14, 3, v1
    v_add_u32 v14, s6, v14
    s_add_u32 s56, s32, 0xa00000
    s_addc_u32 s57, s33, 0
    s_mov_b32 s58, 0x600000
    s_mov_b32 s59, 0x00020000
    s_lshl_b32 s52, s35, 3
    s_add_u32 s52, s52, s61
    s_lshl_b32 s52, s52, 8
    s_add_u32 s52, s52, 262144
    s_barrier
    ds_read_b128 v[24:27], v6 offset:24576
    ds_read_b128 v[28:31], v6 offset:25600
    ds_read_b128 v[32:35], v6 offset:26624
    ds_read_b128 v[36:39], v6 offset:27648
    ds_read_b128 v[40:43], v6 offset:28672
    ds_read_b128 v[44:47], v6 offset:29696
    ds_read_b128 v[48:51], v6 offset:30720
    ds_read_b128 v[52:55], v6 offset:31744
    ds_read_b128 v[56:59], v6 offset:32768
    ds_read_b128 v[60:63], v6 offset:33792
    ds_read_b128 v[64:67], v6 offset:34816
    ds_read_b128 v[68:71], v6 offset:35840
    v_and_b32 v16, 15, v1
    v_lshlrev_b32 v16, 3, v16
    s_mov_b32 s53, 262144
L_pg_20:
    buffer_load_dwordx2 v[18:19], v16, s[64:67], s52 offen sc1
    s_sub_u32 s53, s53, 1
    s_cmp_eq_u32 s53, 0
    s_cbranch_scc1 L_pg_20_x
    s_waitcnt vmcnt(0)
    v_cmp_ne_u64 vcc, s[94:95], v[18:19]
    s_cbranch_vccnz L_pg_20
L_pg_20_x:
    buffer_load_dwordx4 v[192:195], v13, s[48:51], 0 offen offset:0 sc1
    buffer_load_dwordx4 v[196:199], v13, s[48:51], 0 offen offset:1024 sc1
    buffer_load_dwordx4 v[120:123], v7, s[40:43], 0 offen offset:0 sc1
    s_mov_b32 s6, 20480
    buffer_load_dwordx4 v[124:127], v7, s[40:43], s6 offen offset:0 sc1
    buffer_load_dwordx4 v[128:131], v7, s[40:43], 0 offen offset:1024 sc1
    s_mov_b32 s6, 20480
    buffer_load_dwordx4 v[132:135], v7, s[40:43], s6 offen offset:1024 sc1
    buffer_load_dwordx4 v[136:139], v7, s[40:43], 0 offen offset:2048 sc1
    s_mov_b32 s6, 20480
    buffer_load_dwordx4 v[140:143], v7, s[40:43], s6 offen offset:2048 sc1
    buffer_load_dwordx4 v[144:147], v7, s[40:43], 0 offen offset:3072 sc1
    s_mov_b32 s6, 20480
    buffer_load_dwordx4 v[148:151], v7, s[40:43], s6 offen offset:3072 sc1
    s_waitcnt vmcnt(6) lgkmcnt(6)
    ds_read_b128 v[72:75], v6 offset:36864
    v_mfma_f32_16x16x32_bf16 v[200:203], v[24:27], v[120:123], 0
    v_mfma_f32_16x16x32_bf16 v[224:227], v[24:27], v[124:127], 0
    ds_read_b128 v[76:79], v6 offset:37888
    v_mfma_f32_16x16x32_bf16 v[204:207], v[28:31], v[120:123], 0
    v_mfma_f32_16x16x32_bf16 v[228:231], v[28:31], v[124:127], 0
    ds_read_b128 v[80:83], v6 offset:38912
    v_mfma_f32_16x16x32_bf16 v[208:211], v[32:35], v[120:123], 0
    v_mfma_f32_16x16x32_bf16 v[232:235], v[32:35], v[124:127], 0
    ds_read_b128 v[84:87], v6 offset:39936
    v_mfma_f32_16x16x32_bf16 v[212:215], v[36:39], v[120:123], 0
    v_mfma_f32_16x16x32_bf16 v[236:239], v[36:39], v[124:127], 0
    ds_read_b128 v[88:91], v6 offset:40960
    v_mfma_f32_16x16x32_bf16 v[216:219], v[40:43], v[120:123], 0
    v_mfma_f32_16x16x32_bf16 v[240:243], v[40:43], v[124:127], 0
    ds_read_b128 v[92:95], v6 offset:41984
    v_mfma_f32_16x16x32_bf16 v[220:223], v[44:47], v[120:123], 0
    v_mfma_f32_16x16x32_bf16 v[244:247], v[44:47], v[124:127], 0
    s_mov_b32 s6, 4096
    buffer_load_dwordx4 v[152:155], v7, s[40:43], s6 offen offset:0 sc1
    s_mov_b32 s6, 24576
    buffer_load_dwordx4 v[156:159], v7, s[40:43], s6 offen offset:0 sc1
    s_mov_b32 s6, 4096
    buffer_load_dwordx4 v[160:163], v7, s[40:43], s6 offen offset:1024 sc1
    s_mov_b32 s6, 24576
    buffer_load_dwordx4 v[164:167], v7, s[40:43], s6 offen offset:1024 sc1
    s_mov_b32 s6, 4096
    buffer_load_dwordx4 v[168:171], v7, s[40:43], s6 offen offset:2048 sc1
    s_mov_b32 s6, 24576
    buffer_load_dwordx4 v[172:175], v7, s[40:43], s6 offen offset:2048 sc1
    s_waitcnt vmcnt(10) lgkmcnt(6)
    ds_read_b128 v[96:99], v6 offset:43008
    v_mfma_f32_16x16x32_bf16 v[200:203], v[48:51], v[128:131], v[200:203]
    v_mfma_f32_16x16x32_bf16 v[224:227], v[48:51], v[132:135], v[224:227]
    ds_read_b128 v[100:103], v6 offset:44032
    v_mfma_f32_16x16x32_bf16 v[204:207], v[52:55], v[128:131], v[204:207]
    v_mfma_f32_16x16x32_bf16 v[228:231], v[52:55], v[132:135], v[228:231]
    ds_read_b128 v[104:107], v6 offset:45056
    v_mfma_f32_16x16x32_bf16 v[208:211], v[56:59], v[128:131], v[208:211]
    v_mfma_f32_16x16x32_bf16 v[232:235], v[56:59], v[132:135], v[232:235]
    ds_read_b128 v[108:111], v6 offset:46080
    v_mfma_f32_16x16x32_bf16 v[212:215], v[60:63], v[128:131], v[212:215]
    v_mfma_f32_16x16x32_bf16 v[236:239], v[60:63], v[132:135], v[236:239]
    ds_read_b128 v[112:115], v6 offset:47104
    v_mfma_f32_16x16x32_bf16 v[216:219], v[64:67], v[128:131], v[216:219]
    v_mfma_f32_16x16x32_bf16 v[240:243], v[64:67], v[132:135], v[240:243]
    ds_read_b128 v[116:119], v6 offset:48128
    v_mfma_f32_16x16x32_bf16 v[220:223], v[68:71], v[128:131], v[220:223]
    v_mfma_f32_16x16x32_bf16 v[244:247], v[68:71], v[132:135], v[244:247]
    s_mov_b32 s6, 4096
    buffer_load_dwordx4 v[176:179], v7, s[40:43], s6 offen offset:3072 sc1
    s_mov_b32 s6, 24576
    buffer_load_dwordx4 v[180:183], v7, s[40:43], s6 offen offset:3072 sc1
    s_mov_b32 s6, 8192
    buffer_load_dwordx4 v[184:187], v7, s[40:43], s6 offen offset:0 sc1
    s_mov_b32 s6, 28672
    buffer_load_dwordx4 v[188:191], v7, s[40:43], s6 offen offset:0 sc1
    s_mov_b32 s6, 8192
    buffer_load_dwordx4 v[120:123], v7, s[40:43], s6 offen offset:1024 sc1
    s_mov_b32 s6, 28672
    buffer_load_dwordx4 v[124:127], v7, s[40:43], s6 offen offset:1024 sc1
    s_waitcnt vmcnt(14) lgkmcnt(6)
    ds_read_b128 v[24:27], v4 offset:0
    v_mfma_f32_16x16x32_bf16 v[200:203], v[72:75], v[136:139], v[200:203]
    v_mfma_f32_16x16x32_bf16 v[224:227], v[72:75], v[140:143], v[224:227]
    ds_read_b128 v[28:31], v4 offset:1024
    v_mfma_f32_16x16x32_bf16 v[204:207], v[76:79], v[136:139], v[204:207]
    v_mfma_f32_16x16x32_bf16 v[228:231], v[76:79], v[140:143], v[228:231]
    ds_read_b128 v[32:35], v4 offset:2048
    v_mfma_f32_16x16x32_bf16 v[208:211], v[80:83], v[136:139], v[208:211]
    v_mfma_f32_16x16x32_bf16 v[232:235], v[80:83], v[140:143], v[232:235]
    ds_read_b128 v[36:39], v4 offset:3072
    v_mfma_f32_16x16x32_bf16 v[212:215], v[84:87], v[136:139], v[212:215]
    v_mfma_f32_16x16x32_bf16 v[236:239], v[84:87], v[140:143], v[236:239]
    ds_read_b128 v[40:43], v4 offset:4096
    v_mfma_f32_16x16x32_bf16 v[216:219], v[88:91], v[136:139], v[216:219]
    v_mfma_f32_16x16x32_bf16 v[240:243], v[88:91], v[140:143], v[240:243]
    ds_read_b128 v[44:47], v4 offset:5120
    v_mfma_f32_16x16x32_bf16 v[220:223], v[92:95], v[136:139], v[220:223]
    v_mfma_f32_16x16x32_bf16 v[244:247], v[92:95], v[140:143], v[244:247]
    s_mov_b32 s6, 8192
    buffer_load_dwordx4 v[128:131], v7, s[40:43], s6 offen offset:2048 sc1
    s_mov_b32 s6, 28672
    buffer_load_dwordx4 v[132:135], v7, s[40:43], s6 offen offset:2048 sc1
    s_mov_b32 s6, 8192
    buffer_load_dwordx4 v[136:139], v7, s[40:43], s6 offen offset:3072 sc1
    s_mov_b32 s6, 28672
    buffer_load_dwordx4 v[140:143], v7, s[40:43], s6 offen offset:3072 sc1
    s_waitcnt vmcnt(16) lgkmcnt(6)
    ds_read_b128 v[48:51], v4 offset:6144
    ds_read_b128 v[52:55], v4 offset:7168
    ds_read_b128 v[56:59], v4 offset:8192
    ds_read_b128 v[60:63], v4 offset:9216
    v_mfma_f32_16x16x32_bf16 v[200:203], v[96:99], v[144:147], v[200:203]
    ds_read_b128 v[64:67], v4 offset:10240
    ds_read_b128 v[68:71], v4 offset:11264
    v_add_f32 v192, v192, v194
    v_mfma_f32_16x16x32_bf16 v[224:227], v[96:99], v[148:151], v[224:227]
    v_add_f32 v193, v193, v195
    v_add_f32 v196, v196, v198
    v_add_f32 v197, v197, v199
    v_mfma_f32_16x16x32_bf16 v[204:207], v[100:103], v[144:147], v[204:207]
    v_mov_b32 v16, v192
    v_mov_b32 v17, v193
    v_mov_b32 v18, v196
    v_mfma_f32_16x16x32_bf16 v[228:231], v[100:103], v[148:151], v[228:231]
    v_mov_b32 v19, v197
    s_nop 1
    v_permlane16_swap_b32 v192, v16
    v_mfma_f32_16x16x32_bf16 v[208:211], v[104:107], v[144:147], v[208:211]
    v_permlane16_swap_b32 v193, v17
    v_permlane16_swap_b32 v196, v18
    v_permlane16_swap_b32 v197, v19
    v_mfma_f32_16x16x32_bf16 v[232:235], v[104:107], v[148:151], v[232:235]
    s_nop 1
    v_add_f32 v192, v192, v16
    v_add_f32 v193, v193, v17
    v_add_f32 v196, v196, v18
    v_mfma_f32_16x16x32_bf16 v[212:215], v[108:111], v[144:147], v[212:215]
    v_add_f32 v197, v197, v19
    v_mov_b32 v16, v192
    v_mov_b32 v17, v193
    v_mfma_f32_16x16x32_bf16 v[236:239], v[108:111], v[148:151], v[236:239]
    v_mov_b32 v18, v196
    v_mov_b32 v19, v197
    s_nop 1
    v_mfma_f32_16x16x32_bf16 v[216:219], v[112:115], v[144:147], v[216:219]
    v_permlane32_swap_b32 v192, v16
    v_permlane32_swap_b32 v193, v17
    v_permlane32_swap_b32 v196, v18
    v_mfma_f32_16x16x32_bf16 v[240:243], v[112:115], v[148:151], v[240:243]
    v_permlane32_swap_b32 v197, v19
    s_nop 1
    v_add_f32 v192, v192, v16
    v_mfma_f32_16x16x32_bf16 v[220:223], v[116:119], v[144:147], v[220:223]
    v_add_f32 v193, v193, v17
    v_add_f32 v196, v196, v18
    v_add_f32 v197, v197, v19
    v_mfma_f32_16x16x32_bf16 v[244:247], v[116:119], v[148:151], v[244:247]
    s_mov_b32 s6, 12288
    buffer_load_dwordx4 v[144:147], v7, s[40:43], s6 offen offset:0 sc1
    s_mov_b32 s6, 32768
    buffer_load_dwordx4 v[148:151], v7, s[40:43], s6 offen offset:0 sc1
    s_waitcnt vmcnt(16) lgkmcnt(6)
    ds_read_b128 v[72:75], v4 offset:12288
    v_mfma_f32_16x16x32_bf16 v[200:203], v[24:27], v[152:155], v[200:203]
    v_mfma_f32_16x16x32_bf16 v[224:227], v[24:27], v[156:159], v[224:227]
    ds_read_b128 v[76:79], v4 offset:13312
    v_mfma_f32_16x16x32_bf16 v[204:207], v[28:31], v[152:155], v[204:207]
    v_mfma_f32_16x16x32_bf16 v[228:231], v[28:31], v[156:159], v[228:231]
    ds_read_b128 v[80:83], v4 offset:14336
    v_mfma_f32_16x16x32_bf16 v[208:211], v[32:35], v[152:155], v[208:211]
    v_mfma_f32_16x16x32_bf16 v[232:235], v[32:35], v[156:159], v[232:235]
    ds_read_b128 v[84:87], v4 offset:15360
    v_mfma_f32_16x16x32_bf16 v[212:215], v[36:39], v[152:155], v[212:215]
    v_mfma_f32_16x16x32_bf16 v[236:239], v[36:39], v[156:159], v[236:239]
    ds_read_b128 v[88:91], v4 offset:16384
    v_mfma_f32_16x16x32_bf16 v[216:219], v[40:43], v[152:155], v[216:219]
    v_mfma_f32_16x16x32_bf16 v[240:243], v[40:43], v[156:159], v[240:243]
    ds_read_b128 v[92:95], v4 offset:17408
    v_mfma_f32_16x16x32_bf16 v[220:223], v[44:47], v[152:155], v[220:223]
    v_mfma_f32_16x16x32_bf16 v[244:247], v[44:47], v[156:159], v[244:247]
    s_mov_b32 s6, 12288
    buffer_load_dwordx4 v[152:155], v7, s[40:43], s6 offen offset:1024 sc1
    s_mov_b32 s6, 32768
    buffer_load_dwordx4 v[156:159], v7, s[40:43], s6 offen offset:1024 sc1
    s_waitcnt vmcnt(16) lgkmcnt(6)
    ds_read_b128 v[96:99], v4 offset:18432
    ds_read_b128 v[100:103], v4 offset:19456
    ds_read_b128 v[104:107], v4 offset:20480
    v_mfma_f32_16x16x32_bf16 v[200:203], v[48:51], v[160:163], v[200:203]
    ds_read_b128 v[108:111], v4 offset:21504
    ds_read_b128 v[112:115], v4 offset:22528
    v_mfma_f32_16x16x32_bf16 v[224:227], v[48:51], v[164:167], v[224:227]
    ds_read_b128 v[116:119], v4 offset:23552
    v_mul_f32 v194, 0x3acccccd, v192
    v_mfma_f32_16x16x32_bf16 v[204:207], v[52:55], v[160:163], v[204:207]
    v_mul_f32 v20, 0x3acccccd, v193
    v_fma_f32 v20, -v194, v194, v20
    v_mfma_f32_16x16x32_bf16 v[228:231], v[52:55], v[164:167], v[228:231]
    v_max_f32 v20, 0, v20
    v_cvt_pk_bf16_f32 v20, v20, v20
    v_mfma_f32_16x16x32_bf16 v[208:211], v[56:59], v[160:163], v[208:211]
    v_lshlrev_b32 v20, 16, v20
    v_add_f32 v20, 0x3727c5ac, v20
    v_mfma_f32_16x16x32_bf16 v[232:235], v[56:59], v[164:167], v[232:235]
    v_cvt_pk_bf16_f32 v20, v20, v20
    v_lshlrev_b32 v20, 16, v20
    v_sqrt_f32 v20, v20
    v_mfma_f32_16x16x32_bf16 v[212:215], v[60:63], v[160:163], v[212:215]
    s_nop 0
    v_cvt_pk_bf16_f32 v20, v20, v20
    v_mfma_f32_16x16x32_bf16 v[236:239], v[60:63], v[164:167], v[236:239]
    v_lshlrev_b32 v20, 16, v20
    v_rcp_f32 v195, v20
    v_mfma_f32_16x16x32_bf16 v[216:219], v[64:67], v[160:163], v[216:219]
    v_cvt_pk_bf16_f32 v194, v194, v194
    v_lshlrev_b32 v194, 16, v194
    v_mfma_f32_16x16x32_bf16 v[240:243], v[64:67], v[164:167], v[240:243]
    v_mul_f32 v192, v195, v195
    v_mov_b32 v193, v192
    v_mfma_f32_16x16x32_bf16 v[220:223], v[68:71], v[160:163], v[220:223]
    v_cvt_pk_bf16_f32 v195, -v194, v20
    v_cvt_pk_bf16_f32 v194, -v194, -v194
    v_mfma_f32_16x16x32_bf16 v[244:247], v[68:71], v[164:167], v[244:247]
    s_mov_b32 s6, 12288
    buffer_load_dwordx4 v[160:163], v7, s[40:43], s6 offen offset:2048 sc1
    s_mov_b32 s6, 32768
    buffer_load_dwordx4 v[164:167], v7, s[40:43], s6 offen offset:2048 sc1
    s_waitcnt vmcnt(16) lgkmcnt(6)
    ds_read_b128 v[24:27], v4 offset:24576
    v_mfma_f32_16x16x32_bf16 v[200:203], v[72:75], v[168:171], v[200:203]
    v_mfma_f32_16x16x32_bf16 v[224:227], v[72:75], v[172:175], v[224:227]
    ds_read_b128 v[28:31], v4 offset:25600
    v_mfma_f32_16x16x32_bf16 v[204:207], v[76:79], v[168:171], v[204:207]
    v_mfma_f32_16x16x32_bf16 v[228:231], v[76:79], v[172:175], v[228:231]
    ds_read_b128 v[32:35], v4 offset:26624
    v_mfma_f32_16x16x32_bf16 v[208:211], v[80:83], v[168:171], v[208:211]
    v_mfma_f32_16x16x32_bf16 v[232:235], v[80:83], v[172:175], v[232:235]
    ds_read_b128 v[36:39], v4 offset:27648
    v_mfma_f32_16x16x32_bf16 v[212:215], v[84:87], v[168:171], v[212:215]
    v_mfma_f32_16x16x32_bf16 v[236:239], v[84:87], v[172:175], v[236:239]
    ds_read_b128 v[40:43], v4 offset:28672
    v_mfma_f32_16x16x32_bf16 v[216:219], v[88:91], v[168:171], v[216:219]
    v_mfma_f32_16x16x32_bf16 v[240:243], v[88:91], v[172:175], v[240:243]
    ds_read_b128 v[44:47], v4 offset:29696
    v_mfma_f32_16x16x32_bf16 v[220:223], v[92:95], v[168:171], v[220:223]
    v_mfma_f32_16x16x32_bf16 v[244:247], v[92:95], v[172:175], v[244:247]
    s_mov_b32 s6, 12288
    buffer_load_dwordx4 v[168:171], v7, s[40:43], s6 offen offset:3072 sc1
    s_mov_b32 s6, 32768
    buffer_load_dwordx4 v[172:175], v7, s[40:43], s6 offen offset:3072 sc1
    s_waitcnt vmcnt(16) lgkmcnt(6)
    ds_read_b128 v[48:51], v4 offset:30720
    ds_read_b128 v[52:55], v4 offset:31744
    ds_read_b128 v[56:59], v4 offset:32768
    v_mfma_f32_16x16x32_bf16 v[200:203], v[96:99], v[176:179], v[200:203]
    ds_read_b128 v[60:63], v4 offset:33792
    ds_read_b128 v[64:67], v4 offset:34816
    v_mfma_f32_16x16x32_bf16 v[224:227], v[96:99], v[180:183], v[224:227]
    ds_read_b128 v[68:71], v4 offset:35840
    v_mul_f32 v198, 0x3acccccd, v196
    v_mfma_f32_16x16x32_bf16 v[204:207], v[100:103], v[176:179], v[204:207]
    v_mul_f32 v21, 0x3acccccd, v197
    v_fma_f32 v21, -v198, v198, v21
    v_mfma_f32_16x16x32_bf16 v[228:231], v[100:103], v[180:183], v[228:231]
    v_max_f32 v21, 0, v21
    v_cvt_pk_bf16_f32 v21, v21, v21
    v_mfma_f32_16x16x32_bf16 v[208:211], v[104:107], v[176:179], v[208:211]
    v_lshlrev_b32 v21, 16, v21
    v_add_f32 v21, 0x3727c5ac, v21
    v_mfma_f32_16x16x32_bf16 v[232:235], v[104:107], v[180:183], v[232:235]
    v_cvt_pk_bf16_f32 v21, v21, v21
    v_lshlrev_b32 v21, 16, v21
    v_sqrt_f32 v21, v21
    v_mfma_f32_16x16x32_bf16 v[212:215], v[108:111], v[176:179], v[212:215]
    s_nop 0
    v_cvt_pk_bf16_f32 v21, v21, v21
    v_mfma_f32_16x16x32_bf16 v[236:239], v[108:111], v[180:183], v[236:239]
    v_lshlrev_b32 v21, 16, v21
    v_rcp_f32 v199, v21
    v_mfma_f32_16x16x32_bf16 v[216:219], v[112:115], v[176:179], v[216:219]
    v_cvt_pk_bf16_f32 v198, v198, v198
    v_lshlrev_b32 v198, 16, v198
    v_mfma_f32_16x16x32_bf16 v[240:243], v[112:115], v[180:183], v[240:243]
    v_mul_f32 v196, v199, v199
    v_mov_b32 v197, v196
    v_mfma_f32_16x16x32_bf16 v[220:223], v[116:119], v[176:179], v[220:223]
    v_cvt_pk_bf16_f32 v199, -v198, v21
    v_cvt_pk_bf16_f32 v198, -v198, -v198
    v_mfma_f32_16x16x32_bf16 v[244:247], v[116:119], v[180:183], v[244:247]
    s_mov_b32 s6, 16384
    buffer_load_dwordx4 v[176:179], v7, s[40:43], s6 offen offset:0 sc1
    s_mov_b32 s6, 36864
    buffer_load_dwordx4 v[180:183], v7, s[40:43], s6 offen offset:0 sc1
    s_barrier
    s_waitcnt vmcnt(16) lgkmcnt(6)
    ds_read_b128 v[72:75], v4 offset:36864
    v_mfma_f32_16x16x32_bf16 v[200:203], v[24:27], v[184:187], v[200:203]
    v_mfma_f32_16x16x32_bf16 v[224:227], v[24:27], v[188:191], v[224:227]
    ds_read_b128 v[76:79], v4 offset:37888
    v_mfma_f32_16x16x32_bf16 v[204:207], v[28:31], v[184:187], v[204:207]
    v_mfma_f32_16x16x32_bf16 v[228:231], v[28:31], v[188:191], v[228:231]
    ds_read_b128 v[80:83], v4 offset:38912
    v_mfma_f32_16x16x32_bf16 v[208:211], v[32:35], v[184:187], v[208:211]
    v_mfma_f32_16x16x32_bf16 v[232:235], v[32:35], v[188:191], v[232:235]
    ds_read_b128 v[84:87], v4 offset:39936
    v_mfma_f32_16x16x32_bf16 v[212:215], v[36:39], v[184:187], v[212:215]
    v_mfma_f32_16x16x32_bf16 v[236:239], v[36:39], v[188:191], v[236:239]
    ds_read_b128 v[88:91], v4 offset:40960
    v_mfma_f32_16x16x32_bf16 v[216:219], v[40:43], v[184:187], v[216:219]
    v_mfma_f32_16x16x32_bf16 v[240:243], v[40:43], v[188:191], v[240:243]
    ds_read_b128 v[92:95], v4 offset:41984
    v_mfma_f32_16x16x32_bf16 v[220:223], v[44:47], v[184:187], v[220:223]
    v_mfma_f32_16x16x32_bf16 v[244:247], v[44:47], v[188:191], v[244:247]
    s_mov_b32 s6, 16384
    buffer_load_dwordx4 v[184:187], v7, s[40:43], s6 offen offset:1024 sc1
    s_mov_b32 s6, 36864
    buffer_load_dwordx4 v[188:191], v7, s[40:43], s6 offen offset:1024 sc1
    s_waitcnt vmcnt(16) lgkmcnt(6)
    ds_read_b128 v[96:99], v4 offset:43008
    v_mfma_f32_16x16x32_bf16 v[200:203], v[48:51], v[120:123], v[200:203]
    v_mfma_f32_16x16x32_bf16 v[224:227], v[48:51], v[124:127], v[224:227]
    ds_read_b128 v[100:103], v4 offset:44032
    v_mfma_f32_16x16x32_bf16 v[204:207], v[52:55], v[120:123], v[204:207]
    v_mfma_f32_16x16x32_bf16 v[228:231], v[52:55], v[124:127], v[228:231]
    ds_read_b128 v[104:107], v4 offset:45056
    v_mfma_f32_16x16x32_bf16 v[208:211], v[56:59], v[120:123], v[208:211]
    v_mfma_f32_16x16x32_bf16 v[232:235], v[56:59], v[124:127], v[232:235]
    ds_read_b128 v[108:111], v4 offset:46080
    v_mfma_f32_16x16x32_bf16 v[212:215], v[60:63], v[120:123], v[212:215]
    v_mfma_f32_16x16x32_bf16 v[236:239], v[60:63], v[124:127], v[236:239]
    ds_read_b128 v[112:115], v4 offset:47104
    v_mfma_f32_16x16x32_bf16 v[216:219], v[64:67], v[120:123], v[216:219]
    v_mfma_f32_16x16x32_bf16 v[240:243], v[64:67], v[124:127], v[240:243]
    ds_read_b128 v[116:119], v4 offset:48128
    v_mfma_f32_16x16x32_bf16 v[220:223], v[68:71], v[120:123], v[220:223]
    v_mfma_f32_16x16x32_bf16 v[244:247], v[68:71], v[124:127], v[244:247]
    s_mov_b32 s6, 16384
    buffer_load_dwordx4 v[120:123], v7, s[40:43], s6 offen offset:2048 sc1
    s_mov_b32 s6, 36864
    buffer_load_dwordx4 v[124:127], v7, s[40:43], s6 offen offset:2048 sc1
    s_waitcnt vmcnt(16) lgkmcnt(6)
    ds_read_b128 v[24:27], v5 offset:0
    v_mfma_f32_16x16x32_bf16 v[200:203], v[72:75], v[128:131], v[200:203]
    v_mfma_f32_16x16x32_bf16 v[224:227], v[72:75], v[132:135], v[224:227]
    ds_read_b128 v[28:31], v5 offset:1024
    v_mfma_f32_16x16x32_bf16 v[204:207], v[76:79], v[128:131], v[204:207]
    v_mfma_f32_16x16x32_bf16 v[228:231], v[76:79], v[132:135], v[228:231]
    ds_read_b128 v[32:35], v5 offset:2048
    v_mfma_f32_16x16x32_bf16 v[208:211], v[80:83], v[128:131], v[208:211]
    v_mfma_f32_16x16x32_bf16 v[232:235], v[80:83], v[132:135], v[232:235]
    ds_read_b128 v[36:39], v5 offset:3072
    v_mfma_f32_16x16x32_bf16 v[212:215], v[84:87], v[128:131], v[212:215]
    v_mfma_f32_16x16x32_bf16 v[236:239], v[84:87], v[132:135], v[236:239]
    ds_read_b128 v[40:43], v5 offset:4096
    v_mfma_f32_16x16x32_bf16 v[216:219], v[88:91], v[128:131], v[216:219]
    v_mfma_f32_16x16x32_bf16 v[240:243], v[88:91], v[132:135], v[240:243]
    ds_read_b128 v[44:47], v5 offset:5120
    v_mfma_f32_16x16x32_bf16 v[220:223], v[92:95], v[128:131], v[220:223]
    v_mfma_f32_16x16x32_bf16 v[244:247], v[92:95], v[132:135], v[244:247]
    s_mov_b32 s6, 16384
    buffer_load_dwordx4 v[128:131], v7, s[40:43], s6 offen offset:3072 sc1
    s_mov_b32 s6, 36864
    buffer_load_dwordx4 v[132:135], v7, s[40:43], s6 offen offset:3072 sc1
    s_waitcnt vmcnt(16) lgkmcnt(6)
    ds_read_b128 v[48:51], v5 offset:6144
    v_mfma_f32_16x16x32_bf16 v[200:203], v[96:99], v[136:139], v[200:203]
    v_mfma_f32_16x16x32_bf16 v[224:227], v[96:99], v[140:143], v[224:227]
    ds_read_b128 v[52:55], v5 offset:7168
    v_mfma_f32_16x16x32_bf16 v[204:207], v[100:103], v[136:139], v[204:207]
    v_mfma_f32_16x16x32_bf16 v[228:231], v[100:103], v[140:143], v[228:231]
    ds_read_b128 v[56:59], v5 offset:8192
    v_mfma_f32_16x16x32_bf16 v[208:211], v[104:107], v[136:139], v[208:211]
    v_mfma_f32_16x16x32_bf16 v[232:235], v[104:107], v[140:143], v[232:235]
    ds_read_b128 v[60:63], v5 offset:9216
    v_mfma_f32_16x16x32_bf16 v[212:215], v[108:111], v[136:139], v[212:215]
    v_mfma_f32_16x16x32_bf16 v[236:239], v[108:111], v[140:143], v[236:239]
    ds_read_b128 v[64:67], v5 offset:10240
    v_mfma_f32_16x16x32_bf16 v[216:219], v[112:115], v[136:139], v[216:219]
    v_mfma_f32_16x16x32_bf16 v[240:243], v[112:115], v[140:143], v[240:243]
    ds_read_b128 v[68:71], v5 offset:11264
    v_mfma_f32_16x16x32_bf16 v[220:223], v[116:119], v[136:139], v[220:223]
    v_mfma_f32_16x16x32_bf16 v[244:247], v[116:119], v[140:143], v[244:247]
    s_waitcnt vmcnt(14) lgkmcnt(6)
    ds_read_b128 v[72:75], v5 offset:12288
    v_mfma_f32_16x16x32_bf16 v[200:203], v[24:27], v[144:147], v[200:203]
    v_mfma_f32_16x16x32_bf16 v[224:227], v[24:27], v[148:151], v[224:227]
    ds_read_b128 v[76:79], v5 offset:13312
    v_mfma_f32_16x16x32_bf16 v[204:207], v[28:31], v[144:147], v[204:207]
    v_mfma_f32_16x16x32_bf16 v[228:231], v[28:31], v[148:151], v[228:231]
    ds_read_b128 v[80:83], v5 offset:14336
    v_mfma_f32_16x16x32_bf16 v[208:211], v[32:35], v[144:147], v[208:211]
    v_mfma_f32_16x16x32_bf16 v[232:235], v[32:35], v[148:151], v[232:235]
    ds_read_b128 v[84:87], v5 offset:15360
    v_mfma_f32_16x16x32_bf16 v[212:215], v[36:39], v[144:147], v[212:215]
    v_mfma_f32_16x16x32_bf16 v[236:239], v[36:39], v[148:151], v[236:239]
    ds_read_b128 v[88:91], v5 offset:16384
    v_mfma_f32_16x16x32_bf16 v[216:219], v[40:43], v[144:147], v[216:219]
    v_mfma_f32_16x16x32_bf16 v[240:243], v[40:43], v[148:151], v[240:243]
    ds_read_b128 v[92:95], v5 offset:17408
    v_mfma_f32_16x16x32_bf16 v[220:223], v[44:47], v[144:147], v[220:223]
    v_mfma_f32_16x16x32_bf16 v[244:247], v[44:47], v[148:151], v[244:247]
    s_waitcnt vmcnt(12) lgkmcnt(6)
    ds_read_b128 v[96:99], v5 offset:18432
    v_mfma_f32_16x16x32_bf16 v[200:203], v[48:51], v[152:155], v[200:203]
    v_mfma_f32_16x16x32_bf16 v[224:227], v[48:51], v[156:159], v[224:227]
    ds_read_b128 v[100:103], v5 offset:19456
    v_mfma_f32_16x16x32_bf16 v[204:207], v[52:55], v[152:155], v[204:207]
    v_mfma_f32_16x16x32_bf16 v[228:231], v[52:55], v[156:159], v[228:231]
    ds_read_b128 v[104:107], v5 offset:20480
    v_mfma_f32_16x16x32_bf16 v[208:211], v[56:59], v[152:155], v[208:211]
    v_mfma_f32_16x16x32_bf16 v[232:235], v[56:59], v[156:159], v[232:235]
    ds_read_b128 v[108:111], v5 offset:21504
    v_mfma_f32_16x16x32_bf16 v[212:215], v[60:63], v[152:155], v[212:215]
    v_mfma_f32_16x16x32_bf16 v[236:239], v[60:63], v[156:159], v[236:239]
    ds_read_b128 v[112:115], v5 offset:22528
    v_mfma_f32_16x16x32_bf16 v[216:219], v[64:67], v[152:155], v[216:219]
    v_mfma_f32_16x16x32_bf16 v[240:243], v[64:67], v[156:159], v[240:243]
    ds_read_b128 v[116:119], v5 offset:23552
    v_mfma_f32_16x16x32_bf16 v[220:223], v[68:71], v[152:155], v[220:223]
    v_mfma_f32_16x16x32_bf16 v[244:247], v[68:71], v[156:159], v[244:247]
    s_waitcnt vmcnt(10) lgkmcnt(6)
    ds_read_b128 v[24:27], v5 offset:24576
    v_mfma_f32_16x16x32_bf16 v[200:203], v[72:75], v[160:163], v[200:203]
    v_mfma_f32_16x16x32_bf16 v[224:227], v[72:75], v[164:167], v[224:227]
    ds_read_b128 v[28:31], v5 offset:25600
    v_mfma_f32_16x16x32_bf16 v[204:207], v[76:79], v[160:163], v[204:207]
    v_mfma_f32_16x16x32_bf16 v[228:231], v[76:79], v[164:167], v[228:231]
    ds_read_b128 v[32:35], v5 offset:26624
    v_mfma_f32_16x16x32_bf16 v[208:211], v[80:83], v[160:163], v[208:211]
    v_mfma_f32_16x16x32_bf16 v[232:235], v[80:83], v[164:167], v[232:235]
    ds_read_b128 v[36:39], v5 offset:27648
    v_mfma_f32_16x16x32_bf16 v[212:215], v[84:87], v[160:163], v[212:215]
    v_mfma_f32_16x16x32_bf16 v[236:239], v[84:87], v[164:167], v[236:239]
    ds_read_b128 v[40:43], v5 offset:28672
    v_mfma_f32_16x16x32_bf16 v[216:219], v[88:91], v[160:163], v[216:219]
    v_mfma_f32_16x16x32_bf16 v[240:243], v[88:91], v[164:167], v[240:243]
    ds_read_b128 v[44:47], v5 offset:29696
    v_mfma_f32_16x16x32_bf16 v[220:223], v[92:95], v[160:163], v[220:223]
    v_mfma_f32_16x16x32_bf16 v[244:247], v[92:95], v[164:167], v[244:247]
    s_waitcnt vmcnt(8) lgkmcnt(6)
    ds_read_b128 v[48:51], v5 offset:30720
    v_mfma_f32_16x16x32_bf16 v[200:203], v[96:99], v[168:171], v[200:203]
    v_mfma_f32_16x16x32_bf16 v[224:227], v[96:99], v[172:175], v[224:227]
    ds_read_b128 v[52:55], v5 offset:31744
    v_mfma_f32_16x16x32_bf16 v[204:207], v[100:103], v[168:171], v[204:207]
    v_mfma_f32_16x16x32_bf16 v[228:231], v[100:103], v[172:175], v[228:231]
    ds_read_b128 v[56:59], v5 offset:32768
    v_mfma_f32_16x16x32_bf16 v[208:211], v[104:107], v[168:171], v[208:211]
    v_mfma_f32_16x16x32_bf16 v[232:235], v[104:107], v[172:175], v[232:235]
    ds_read_b128 v[60:63], v5 offset:33792
    v_mfma_f32_16x16x32_bf16 v[212:215], v[108:111], v[168:171], v[212:215]
    v_mfma_f32_16x16x32_bf16 v[236:239], v[108:111], v[172:175], v[236:239]
    ds_read_b128 v[64:67], v5 offset:34816
    v_mfma_f32_16x16x32_bf16 v[216:219], v[112:115], v[168:171], v[216:219]
    v_mfma_f32_16x16x32_bf16 v[240:243], v[112:115], v[172:175], v[240:243]
    ds_read_b128 v[68:71], v5 offset:35840
    v_mfma_f32_16x16x32_bf16 v[220:223], v[116:119], v[168:171], v[220:223]
    v_mfma_f32_16x16x32_bf16 v[244:247], v[116:119], v[172:175], v[244:247]
    s_barrier
    s_waitcnt vmcnt(6) lgkmcnt(6)
    ds_read_b128 v[72:75], v5 offset:36864
    v_mfma_f32_16x16x32_bf16 v[200:203], v[24:27], v[176:179], v[200:203]
    v_mfma_f32_16x16x32_bf16 v[224:227], v[24:27], v[180:183], v[224:227]
    ds_read_b128 v[76:79], v5 offset:37888
    v_mfma_f32_16x16x32_bf16 v[204:207], v[28:31], v[176:179], v[204:207]
    v_mfma_f32_16x16x32_bf16 v[228:231], v[28:31], v[180:183], v[228:231]
    ds_read_b128 v[80:83], v5 offset:38912
    v_mfma_f32_16x16x32_bf16 v[208:211], v[32:35], v[176:179], v[208:211]
    v_mfma_f32_16x16x32_bf16 v[232:235], v[32:35], v[180:183], v[232:235]
    ds_read_b128 v[84:87], v5 offset:39936
    v_mfma_f32_16x16x32_bf16 v[212:215], v[36:39], v[176:179], v[212:215]
    v_mfma_f32_16x16x32_bf16 v[236:239], v[36:39], v[180:183], v[236:239]
    ds_read_b128 v[88:91], v5 offset:40960
    v_mfma_f32_16x16x32_bf16 v[216:219], v[40:43], v[176:179], v[216:219]
    v_mfma_f32_16x16x32_bf16 v[240:243], v[40:43], v[180:183], v[240:243]
    ds_read_b128 v[92:95], v5 offset:41984
    v_mfma_f32_16x16x32_bf16 v[220:223], v[44:47], v[176:179], v[220:223]
    v_mfma_f32_16x16x32_bf16 v[244:247], v[44:47], v[180:183], v[244:247]
    buffer_load_dwordx2 v[24:25], v14, s[68:71], 0 offen offset:0 sc1
    buffer_load_dwordx2 v[26:27], v14, s[68:71], 0 offen offset:512 sc1
    buffer_load_dwordx2 v[28:29], v14, s[68:71], 0 offen offset:1024 sc1
    buffer_load_dwordx2 v[30:31], v14, s[68:71], 0 offen offset:1536 sc1
    buffer_load_dwordx2 v[32:33], v14, s[68:71], 0 offen offset:2048 sc1
    buffer_load_dwordx2 v[34:35], v14, s[68:71], 0 offen offset:2560 sc1
    s_waitcnt vmcnt(10) lgkmcnt(6)
    ds_read_b128 v[96:99], v5 offset:43008
    v_mfma_f32_16x16x32_bf16 v[200:203], v[48:51], v[184:187], v[200:203]
    v_mfma_f32_16x16x32_bf16 v[224:227], v[48:51], v[188:191], v[224:227]
    ds_read_b128 v[100:103], v5 offset:44032
    v_mfma_f32_16x16x32_bf16 v[204:207], v[52:55], v[184:187], v[204:207]
    v_mfma_f32_16x16x32_bf16 v[228:231], v[52:55], v[188:191], v[228:231]
    ds_read_b128 v[104:107], v5 offset:45056
    v_mfma_f32_16x16x32_bf16 v[208:211], v[56:59], v[184:187], v[208:211]
    v_mfma_f32_16x16x32_bf16 v[232:235], v[56:59], v[188:191], v[232:235]
    ds_read_b128 v[108:111], v5 offset:46080
    v_mfma_f32_16x16x32_bf16 v[212:215], v[60:63], v[184:187], v[212:215]
    v_mfma_f32_16x16x32_bf16 v[236:239], v[60:63], v[188:191], v[236:239]
    ds_read_b128 v[112:115], v5 offset:47104
    v_mfma_f32_16x16x32_bf16 v[216:219], v[64:67], v[184:187], v[216:219]
    v_mfma_f32_16x16x32_bf16 v[240:243], v[64:67], v[188:191], v[240:243]
    ds_read_b128 v[116:119], v5 offset:48128
    v_mfma_f32_16x16x32_bf16 v[220:223], v[68:71], v[184:187], v[220:223]
    v_mfma_f32_16x16x32_bf16 v[244:247], v[68:71], v[188:191], v[244:247]
    s_waitcnt vmcnt(8) lgkmcnt(6)
    v_mfma_f32_16x16x32_bf16 v[200:203], v[72:75], v[120:123], v[200:203]
    v_mfma_f32_16x16x32_bf16 v[224:227], v[72:75], v[124:127], v[224:227]
    v_mfma_f32_16x16x32_bf16 v[204:207], v[76:79], v[120:123], v[204:207]
    v_mfma_f32_16x16x32_bf16 v[228:231], v[76:79], v[124:127], v[228:231]
    v_mfma_f32_16x16x32_bf16 v[208:211], v[80:83], v[120:123], v[208:211]
    v_mfma_f32_16x16x32_bf16 v[232:235], v[80:83], v[124:127], v[232:235]
    v_mfma_f32_16x16x32_bf16 v[212:215], v[84:87], v[120:123], v[212:215]
    v_mfma_f32_16x16x32_bf16 v[236:239], v[84:87], v[124:127], v[236:239]
    v_mfma_f32_16x16x32_bf16 v[216:219], v[88:91], v[120:123], v[216:219]
    v_mfma_f32_16x16x32_bf16 v[240:243], v[88:91], v[124:127], v[240:243]
    v_mfma_f32_16x16x32_bf16 v[220:223], v[92:95], v[120:123], v[220:223]
    v_mfma_f32_16x16x32_bf16 v[244:247], v[92:95], v[124:127], v[244:247]
    s_waitcnt vmcnt(6) lgkmcnt(0)
    v_mfma_f32_16x16x32_bf16 v[200:203], v[96:99], v[128:131], v[200:203]
    v_mfma_f32_16x16x32_bf16 v[224:227], v[96:99], v[132:135], v[224:227]
    v_mfma_f32_16x16x32_bf16 v[204:207], v[100:103], v[128:131], v[204:207]
    v_mfma_f32_16x16x32_bf16 v[228:231], v[100:103], v[132:135], v[228:231]
    v_mfma_f32_16x16x32_bf16 v[208:211], v[104:107], v[128:131], v[208:211]
    v_mfma_f32_16x16x32_bf16 v[232:235], v[104:107], v[132:135], v[232:235]
    v_mfma_f32_16x16x32_bf16 v[212:215], v[108:111], v[128:131], v[212:215]
    v_mfma_f32_16x16x32_bf16 v[236:239], v[108:111], v[132:135], v[236:239]
    v_mfma_f32_16x16x32_bf16 v[216:219], v[112:115], v[128:131], v[216:219]
    v_mfma_f32_16x16x32_bf16 v[240:243], v[112:115], v[132:135], v[240:243]
    v_mfma_f32_16x16x32_bf16 v[220:223], v[116:119], v[128:131], v[220:223]
    v_mfma_f32_16x16x32_bf16 v[244:247], v[116:119], v[132:135], v[244:247]
    s_waitcnt vmcnt(0)
    v_mfma_f32_16x16x16_bf16 v[200:203], v[24:25], v[194:195], v[200:203]
    v_mfma_f32_16x16x16_bf16 v[224:227], v[24:25], v[198:199], v[224:227]
    v_mfma_f32_16x16x16_bf16 v[204:207], v[26:27], v[194:195], v[204:207]
    v_mfma_f32_16x16x16_bf16 v[228:231], v[26:27], v[198:199], v[228:231]
    v_mfma_f32_16x16x16_bf16 v[208:211], v[28:29], v[194:195], v[208:211]
    v_mfma_f32_16x16x16_bf16 v[232:235], v[28:29], v[198:199], v[232:235]
    v_mfma_f32_16x16x16_bf16 v[212:215], v[30:31], v[194:195], v[212:215]
    v_mfma_f32_16x16x16_bf16 v[236:239], v[30:31], v[198:199], v[236:239]
    v_mfma_f32_16x16x16_bf16 v[216:219], v[32:33], v[194:195], v[216:219]
    v_mfma_f32_16x16x16_bf16 v[240:243], v[32:33], v[198:199], v[240:243]
    v_mfma_f32_16x16x16_bf16 v[220:223], v[34:35], v[194:195], v[220:223]
    v_mfma_f32_16x16x16_bf16 v[244:247], v[34:35], v[198:199], v[244:247]
    s_nop 7
    s_lshl_b32 s52, s35, 11
    s_lshl_b32 s6, s61, 3
    s_add_u32 s52, s52, s6
    s_add_u32 s52, s52, 524288
    s_mov_b32 s6, 49152
    s_cmp_lg_u32 s55, 1
    s_cbranch_scc1 sequential_preLN__grouped_kv_mqa__dense_activation_squared_relu__prompt_kernel_sc_21
    v_max_f32 v200, 0, v200
    v_max_f32 v201, 0, v201
    v_max_f32 v202, 0, v202
    v_max_f32 v203, 0, v203
    v_pk_mul_f32 v[16:17], v[200:201], v[192:193]
    v_pk_mul_f32 v[18:19], v[202:203], v[192:193]
    v_pk_mul_f32 v[200:201], v[200:201], v[16:17]
    v_pk_mul_f32 v[202:203], v[202:203], v[18:19]
    v_cvt_pk_bf16_f32 v200, v200, v201
    v_cvt_pk_bf16_f32 v201, v202, v203
    buffer_store_dwordx2 v[200:201], v12, s[56:59], 0 offen offset:0
    v_max_f32 v224, 0, v224
    v_max_f32 v225, 0, v225
    v_max_f32 v226, 0, v226
    v_max_f32 v227, 0, v227
    v_pk_mul_f32 v[16:17], v[224:225], v[196:197]
    v_pk_mul_f32 v[18:19], v[226:227], v[196:197]
    v_pk_mul_f32 v[224:225], v[224:225], v[16:17]
    v_pk_mul_f32 v[226:227], v[226:227], v[18:19]
    v_cvt_pk_bf16_f32 v224, v224, v225
    v_cvt_pk_bf16_f32 v225, v226, v227
    buffer_store_dwordx2 v[224:225], v12, s[56:59], s6 offen offset:0
    v_max_f32 v204, 0, v204
    v_max_f32 v205, 0, v205
    v_max_f32 v206, 0, v206
    v_max_f32 v207, 0, v207
    v_pk_mul_f32 v[16:17], v[204:205], v[192:193]
    v_pk_mul_f32 v[18:19], v[206:207], v[192:193]
    v_pk_mul_f32 v[204:205], v[204:205], v[16:17]
    v_pk_mul_f32 v[206:207], v[206:207], v[18:19]
    v_cvt_pk_bf16_f32 v204, v204, v205
    v_cvt_pk_bf16_f32 v205, v206, v207
    buffer_store_dwordx2 v[204:205], v12, s[56:59], 0 offen offset:512
    v_max_f32 v228, 0, v228
    v_max_f32 v229, 0, v229
    v_max_f32 v230, 0, v230
    v_max_f32 v231, 0, v231
    v_pk_mul_f32 v[16:17], v[228:229], v[196:197]
    v_pk_mul_f32 v[18:19], v[230:231], v[196:197]
    v_pk_mul_f32 v[228:229], v[228:229], v[16:17]
    v_pk_mul_f32 v[230:231], v[230:231], v[18:19]
    v_cvt_pk_bf16_f32 v228, v228, v229
    v_cvt_pk_bf16_f32 v229, v230, v231
    buffer_store_dwordx2 v[228:229], v12, s[56:59], s6 offen offset:512
    v_max_f32 v208, 0, v208
    v_max_f32 v209, 0, v209
    v_max_f32 v210, 0, v210
    v_max_f32 v211, 0, v211
    v_pk_mul_f32 v[16:17], v[208:209], v[192:193]
    v_pk_mul_f32 v[18:19], v[210:211], v[192:193]
    v_pk_mul_f32 v[208:209], v[208:209], v[16:17]
    v_pk_mul_f32 v[210:211], v[210:211], v[18:19]
    v_cvt_pk_bf16_f32 v208, v208, v209
    v_cvt_pk_bf16_f32 v209, v210, v211
    buffer_store_dwordx2 v[208:209], v12, s[56:59], 0 offen offset:1024
    v_max_f32 v232, 0, v232
    v_max_f32 v233, 0, v233
    v_max_f32 v234, 0, v234
    v_max_f32 v235, 0, v235
    v_pk_mul_f32 v[16:17], v[232:233], v[196:197]
    v_pk_mul_f32 v[18:19], v[234:235], v[196:197]
    v_pk_mul_f32 v[232:233], v[232:233], v[16:17]
    v_pk_mul_f32 v[234:235], v[234:235], v[18:19]
    v_cvt_pk_bf16_f32 v232, v232, v233
    v_cvt_pk_bf16_f32 v233, v234, v235
    buffer_store_dwordx2 v[232:233], v12, s[56:59], s6 offen offset:1024
    v_max_f32 v212, 0, v212
    v_max_f32 v213, 0, v213
    v_max_f32 v214, 0, v214
    v_max_f32 v215, 0, v215
    v_pk_mul_f32 v[16:17], v[212:213], v[192:193]
    v_pk_mul_f32 v[18:19], v[214:215], v[192:193]
    v_pk_mul_f32 v[212:213], v[212:213], v[16:17]
    v_pk_mul_f32 v[214:215], v[214:215], v[18:19]
    v_cvt_pk_bf16_f32 v212, v212, v213
    v_cvt_pk_bf16_f32 v213, v214, v215
    buffer_store_dwordx2 v[212:213], v12, s[56:59], 0 offen offset:1536
    v_max_f32 v236, 0, v236
    v_max_f32 v237, 0, v237
    v_max_f32 v238, 0, v238
    v_max_f32 v239, 0, v239
    v_pk_mul_f32 v[16:17], v[236:237], v[196:197]
    v_pk_mul_f32 v[18:19], v[238:239], v[196:197]
    v_pk_mul_f32 v[236:237], v[236:237], v[16:17]
    v_pk_mul_f32 v[238:239], v[238:239], v[18:19]
    v_cvt_pk_bf16_f32 v236, v236, v237
    v_cvt_pk_bf16_f32 v237, v238, v239
    buffer_store_dwordx2 v[236:237], v12, s[56:59], s6 offen offset:1536
    v_max_f32 v216, 0, v216
    v_max_f32 v217, 0, v217
    v_max_f32 v218, 0, v218
    v_max_f32 v219, 0, v219
    v_pk_mul_f32 v[16:17], v[216:217], v[192:193]
    v_pk_mul_f32 v[18:19], v[218:219], v[192:193]
    v_pk_mul_f32 v[216:217], v[216:217], v[16:17]
    v_pk_mul_f32 v[218:219], v[218:219], v[18:19]
    v_cvt_pk_bf16_f32 v216, v216, v217
    v_cvt_pk_bf16_f32 v217, v218, v219
    buffer_store_dwordx2 v[216:217], v12, s[56:59], 0 offen offset:2048
    v_max_f32 v240, 0, v240
    v_max_f32 v241, 0, v241
    v_max_f32 v242, 0, v242
    v_max_f32 v243, 0, v243
    v_pk_mul_f32 v[16:17], v[240:241], v[196:197]
    v_pk_mul_f32 v[18:19], v[242:243], v[196:197]
    v_pk_mul_f32 v[240:241], v[240:241], v[16:17]
    v_pk_mul_f32 v[242:243], v[242:243], v[18:19]
    v_cvt_pk_bf16_f32 v240, v240, v241
    v_cvt_pk_bf16_f32 v241, v242, v243
    buffer_store_dwordx2 v[240:241], v12, s[56:59], s6 offen offset:2048
    v_max_f32 v220, 0, v220
    v_max_f32 v221, 0, v221
    v_max_f32 v222, 0, v222
    v_max_f32 v223, 0, v223
    v_pk_mul_f32 v[16:17], v[220:221], v[192:193]
    v_pk_mul_f32 v[18:19], v[222:223], v[192:193]
    v_pk_mul_f32 v[220:221], v[220:221], v[16:17]
    v_pk_mul_f32 v[222:223], v[222:223], v[18:19]
    v_cvt_pk_bf16_f32 v220, v220, v221
    v_cvt_pk_bf16_f32 v221, v222, v223
    buffer_store_dwordx2 v[220:221], v12, s[56:59], 0 offen offset:2560
    v_max_f32 v244, 0, v244
    v_max_f32 v245, 0, v245
    v_max_f32 v246, 0, v246
    v_max_f32 v247, 0, v247
    v_pk_mul_f32 v[16:17], v[244:245], v[196:197]
    v_pk_mul_f32 v[18:19], v[246:247], v[196:197]
    v_pk_mul_f32 v[244:245], v[244:245], v[16:17]
    v_pk_mul_f32 v[246:247], v[246:247], v[18:19]
    v_cvt_pk_bf16_f32 v244, v244, v245
    v_cvt_pk_bf16_f32 v245, v246, v247
    buffer_store_dwordx2 v[244:245], v12, s[56:59], s6 offen offset:2560
    v_lshlrev_b32 v16, 8, v1
    v_mov_b32 v18, s94
    v_mov_b32 v19, s95
    s_waitcnt vmcnt(0)
    s_mov_b32 exec_lo, 0xffff
    s_mov_b32 exec_hi, 0x0
    buffer_store_dwordx2 v[18:19], v16, s[64:67], s52 offen
    s_mov_b64 exec, -1
sequential_preLN__grouped_kv_mqa__dense_activation_squared_relu__prompt_kernel_sc_22:
    s_mul_i32 s6, s34, 5120
    v_add_u32 v72, s6, v4
    v_add_u32 v73, s6, v5
    v_add_u32 v74, s6, v6
    s_mul_i32 s6, s62, 49152
    s_lshl_b32 s52, s34, 10
    s_add_u32 s6, s6, s52
    v_add_u32 v7, s6, v4
    s_xor_b32 s6, s62, 1
    s_mul_i32 s6, s6, 49152
    s_add_u32 s6, s6, s52
    v_add_u32 v75, s6, v4
    s_lshl_b32 s6, s3, 10
    s_add_u32 s6, s6, 147456
    v_add_u32 v76, s6, v4
    s_lshr_b32 s6, s3, 1
    s_mul_i32 s6, s6, 10240
    s_sub_u32 s6, s6, 38912
    v_add_u32 v77, s6, v76
    s_xor_b32 s52, s3, 2
    s_lshl_b32 s6, s52, 10
    s_add_u32 s6, s6, 147456
    v_add_u32 v78, s6, v4
    s_lshr_b32 s6, s52, 1
    s_mul_i32 s6, s6, 10240
    s_sub_u32 s6, s6, 38912
    v_add_u32 v79, s6, v78
    v_lshlrev_b32 v20, 1, v10
    s_mov_b32 s40, s26
    s_mov_b32 s41, s27
    s_mov_b32 s42, 0x500
    s_mov_b32 s43, 0x00020000
    buffer_load_dwordx2 v[84:85], v20, s[40:43], 0 offen offset:0
    buffer_load_dwordx2 v[86:87], v20, s[40:43], 0 offen offset:32
    buffer_load_dwordx2 v[88:89], v20, s[40:43], 0 offen offset:64
    buffer_load_dwordx2 v[90:91], v20, s[40:43], 0 offen offset:96
    buffer_load_dwordx2 v[92:93], v20, s[40:43], 0 offen offset:128
    s_mov_b32 s44, s28
    s_mov_b32 s45, s29
    s_mov_b32 s46, 0x280000
    s_mov_b32 s47, 0x00020000
    s_lshl_b32 s63, s62, 3
    s_add_u32 s63, s63, s5
    s_lshl_b32 s63, s63, 8
    s_add_u32 s63, s63, 524288
    s_barrier
    ds_read_b128 v[24:27], v74 offset:0
    ds_read_b128 v[28:31], v74 offset:1024
    ds_read_b128 v[32:35], v74 offset:2048
    ds_read_b128 v[36:39], v74 offset:3072
    ds_read_b128 v[40:43], v74 offset:4096
    s_waitcnt vmcnt(0)
    v_lshlrev_b32 v200, 16, v248
    v_and_b32 v201, 0xffff0000, v248
    v_lshlrev_b32 v16, 16, v84
    v_and_b32 v17, 0xffff0000, v84
    v_pk_add_f32 v[200:201], v[200:201], v[16:17]
    v_lshlrev_b32 v202, 16, v249
    v_and_b32 v203, 0xffff0000, v249
    v_lshlrev_b32 v16, 16, v85
    v_and_b32 v17, 0xffff0000, v85
    v_pk_add_f32 v[202:203], v[202:203], v[16:17]
    v_lshlrev_b32 v204, 16, v250
    v_and_b32 v205, 0xffff0000, v250
    v_lshlrev_b32 v16, 16, v86
    v_and_b32 v17, 0xffff0000, v86
    v_pk_add_f32 v[204:205], v[204:205], v[16:17]
    v_lshlrev_b32 v206, 16, v251
    v_and_b32 v207, 0xffff0000, v251
    v_lshlrev_b32 v16, 16, v87
    v_and_b32 v17, 0xffff0000, v87
    v_pk_add_f32 v[206:207], v[206:207], v[16:17]
    v_lshlrev_b32 v208, 16, v252
    v_and_b32 v209, 0xffff0000, v252
    v_lshlrev_b32 v16, 16, v88
    v_and_b32 v17, 0xffff0000, v88
    v_pk_add_f32 v[208:209], v[208:209], v[16:17]
    v_lshlrev_b32 v210, 16, v253
    v_and_b32 v211, 0xffff0000, v253
    v_lshlrev_b32 v16, 16, v89
    v_and_b32 v17, 0xffff0000, v89
    v_pk_add_f32 v[210:211], v[210:211], v[16:17]
    v_lshlrev_b32 v212, 16, v254
    v_and_b32 v213, 0xffff0000, v254
    v_lshlrev_b32 v16, 16, v90
    v_and_b32 v17, 0xffff0000, v90
    v_pk_add_f32 v[212:213], v[212:213], v[16:17]
    v_lshlrev_b32 v214, 16, v255
    v_and_b32 v215, 0xffff0000, v255
    v_lshlrev_b32 v16, 16, v91
    v_and_b32 v17, 0xffff0000, v91
    v_pk_add_f32 v[214:215], v[214:215], v[16:17]
    v_lshlrev_b32 v216, 16, v2
    v_and_b32 v217, 0xffff0000, v2
    v_lshlrev_b32 v16, 16, v92
    v_and_b32 v17, 0xffff0000, v92
    v_pk_add_f32 v[216:217], v[216:217], v[16:17]
    v_lshlrev_b32 v218, 16, v3
    v_and_b32 v219, 0xffff0000, v3
    v_lshlrev_b32 v16, 16, v93
    v_and_b32 v17, 0xffff0000, v93
    v_pk_add_f32 v[218:219], v[218:219], v[16:17]
    v_and_b32 v16, 15, v1
    v_lshlrev_b32 v16, 3, v16
    s_mov_b32 s53, 262144
L_pg_23:
    buffer_load_dwordx2 v[18:19], v16, s[64:67], s63 offen sc1
    s_sub_u32 s53, s53, 1
    s_cmp_eq_u32 s53, 0
    s_cbranch_scc1 L_pg_23_x
    s_waitcnt vmcnt(0)
    v_cmp_ne_u64 vcc, s[94:95], v[18:19]
    s_cbranch_vccnz L_pg_23
L_pg_23_x:
    buffer_load_dwordx4 v[120:123], v7, s[56:59], 0 offen offset:0 sc1
    buffer_load_dwordx4 v[124:127], v75, s[56:59], 0 offen offset:0 sc1
    buffer_load_dwordx4 v[128:131], v7, s[56:59], 0 offen offset:2048 sc1
    buffer_load_dwordx4 v[132:135], v75, s[56:59], 0 offen offset:2048 sc1
    s_mov_b32 s6, 4096
    buffer_load_dwordx4 v[136:139], v7, s[56:59], s6 offen offset:0 sc1
    buffer_load_dwordx4 v[140:143], v75, s[56:59], s6 offen offset:0 sc1
    s_mov_b32 s6, 4096
    buffer_load_dwordx4 v[144:147], v7, s[56:59], s6 offen offset:2048 sc1
    buffer_load_dwordx4 v[148:151], v75, s[56:59], s6 offen offset:2048 sc1
    s_waitcnt vmcnt(6) lgkmcnt(0)
    ds_read_b128 v[48:51], v74 offset:12288
    v_mfma_f32_16x16x32_bf16 v[200:203], v[24:27], v[120:123], v[200:203]
    ds_read_b128 v[52:55], v74 offset:13312
    v_mfma_f32_16x16x32_bf16 v[220:223], v[24:27], v[124:127], 0
    ds_read_b128 v[56:59], v74 offset:14336
    v_mfma_f32_16x16x32_bf16 v[204:207], v[28:31], v[120:123], v[204:207]
    ds_read_b128 v[60:63], v74 offset:15360
    v_mfma_f32_16x16x32_bf16 v[224:227], v[28:31], v[124:127], 0
    ds_read_b128 v[64:67], v74 offset:16384
    v_mfma_f32_16x16x32_bf16 v[208:211], v[32:35], v[120:123], v[208:211]
    v_mfma_f32_16x16x32_bf16 v[228:231], v[32:35], v[124:127], 0
    v_mfma_f32_16x16x32_bf16 v[212:215], v[36:39], v[120:123], v[212:215]
    v_mfma_f32_16x16x32_bf16 v[232:235], v[36:39], v[124:127], 0
    v_mfma_f32_16x16x32_bf16 v[216:219], v[40:43], v[120:123], v[216:219]
    v_mfma_f32_16x16x32_bf16 v[236:239], v[40:43], v[124:127], 0
    s_mov_b32 s6, 8192
    buffer_load_dwordx4 v[152:155], v7, s[56:59], s6 offen offset:0 sc1
    buffer_load_dwordx4 v[156:159], v75, s[56:59], s6 offen offset:0 sc1
    s_mov_b32 s6, 8192
    buffer_load_dwordx4 v[160:163], v7, s[56:59], s6 offen offset:2048 sc1
    buffer_load_dwordx4 v[164:167], v75, s[56:59], s6 offen offset:2048 sc1
    s_mov_b32 s6, 12288
    buffer_load_dwordx4 v[168:171], v7, s[56:59], s6 offen offset:0 sc1
    buffer_load_dwordx4 v[172:175], v75, s[56:59], s6 offen offset:0 sc1
    s_waitcnt vmcnt(10) lgkmcnt(0)
    ds_read_b128 v[24:27], v74 offset:24576
    v_mfma_f32_16x16x32_bf16 v[200:203], v[48:51], v[128:131], v[200:203]
    ds_read_b128 v[28:31], v74 offset:25600
    v_mfma_f32_16x16x32_bf16 v[220:223], v[48:51], v[132:135], v[220:223]
    ds_read_b128 v[32:35], v74 offset:26624
    v_mfma_f32_16x16x32_bf16 v[204:207], v[52:55], v[128:131], v[204:207]
    ds_read_b128 v[36:39], v74 offset:27648
    v_mfma_f32_16x16x32_bf16 v[224:227], v[52:55], v[132:135], v[224:227]
    ds_read_b128 v[40:43], v74 offset:28672
    v_mfma_f32_16x16x32_bf16 v[208:211], v[56:59], v[128:131], v[208:211]
    v_mfma_f32_16x16x32_bf16 v[228:231], v[56:59], v[132:135], v[228:231]
    v_mfma_f32_16x16x32_bf16 v[212:215], v[60:63], v[128:131], v[212:215]
    v_mfma_f32_16x16x32_bf16 v[232:235], v[60:63], v[132:135], v[232:235]
    v_mfma_f32_16x16x32_bf16 v[216:219], v[64:67], v[128:131], v[216:219]
    v_mfma_f32_16x16x32_bf16 v[236:239], v[64:67], v[132:135], v[236:239]
    s_mov_b32 s6, 12288
    buffer_load_dwordx4 v[176:179], v7, s[56:59], s6 offen offset:2048 sc1
    buffer_load_dwordx4 v[180:183], v75, s[56:59], s6 offen offset:2048 sc1
    s_mov_b32 s6, 16384
    buffer_load_dwordx4 v[120:123], v7, s[56:59], s6 offen offset:0 sc1
    buffer_load_dwordx4 v[124:127], v75, s[56:59], s6 offen offset:0 sc1
    s_mov_b32 s6, 16384
    buffer_load_dwordx4 v[128:131], v7, s[56:59], s6 offen offset:2048 sc1
    buffer_load_dwordx4 v[132:135], v75, s[56:59], s6 offen offset:2048 sc1
    s_waitcnt vmcnt(14) lgkmcnt(0)
    ds_read_b128 v[48:51], v74 offset:36864
    v_mfma_f32_16x16x32_bf16 v[200:203], v[24:27], v[136:139], v[200:203]
    ds_read_b128 v[52:55], v74 offset:37888
    v_mfma_f32_16x16x32_bf16 v[220:223], v[24:27], v[140:143], v[220:223]
    ds_read_b128 v[56:59], v74 offset:38912
    v_mfma_f32_16x16x32_bf16 v[204:207], v[28:31], v[136:139], v[204:207]
    ds_read_b128 v[60:63], v74 offset:39936
    v_mfma_f32_16x16x32_bf16 v[224:227], v[28:31], v[140:143], v[224:227]
    ds_read_b128 v[64:67], v74 offset:40960
    v_mfma_f32_16x16x32_bf16 v[208:211], v[32:35], v[136:139], v[208:211]
    v_mfma_f32_16x16x32_bf16 v[228:231], v[32:35], v[140:143], v[228:231]
    v_mfma_f32_16x16x32_bf16 v[212:215], v[36:39], v[136:139], v[212:215]
    v_mfma_f32_16x16x32_bf16 v[232:235], v[36:39], v[140:143], v[232:235]
    v_mfma_f32_16x16x32_bf16 v[216:219], v[40:43], v[136:139], v[216:219]
    v_mfma_f32_16x16x32_bf16 v[236:239], v[40:43], v[140:143], v[236:239]
    s_mov_b32 s6, 20480
    buffer_load_dwordx4 v[136:139], v7, s[56:59], s6 offen offset:0 sc1
    buffer_load_dwordx4 v[140:143], v75, s[56:59], s6 offen offset:0 sc1
    s_waitcnt vmcnt(14) lgkmcnt(0)
    ds_read_b128 v[24:27], v72 offset:0
    v_mfma_f32_16x16x32_bf16 v[200:203], v[48:51], v[144:147], v[200:203]
    ds_read_b128 v[28:31], v72 offset:1024
    v_mfma_f32_16x16x32_bf16 v[220:223], v[48:51], v[148:151], v[220:223]
    ds_read_b128 v[32:35], v72 offset:2048
    v_mfma_f32_16x16x32_bf16 v[204:207], v[52:55], v[144:147], v[204:207]
    ds_read_b128 v[36:39], v72 offset:3072
    v_mfma_f32_16x16x32_bf16 v[224:227], v[52:55], v[148:151], v[224:227]
    ds_read_b128 v[40:43], v72 offset:4096
    v_mfma_f32_16x16x32_bf16 v[208:211], v[56:59], v[144:147], v[208:211]
    v_mfma_f32_16x16x32_bf16 v[228:231], v[56:59], v[148:151], v[228:231]
    v_mfma_f32_16x16x32_bf16 v[212:215], v[60:63], v[144:147], v[212:215]
    v_mfma_f32_16x16x32_bf16 v[232:235], v[60:63], v[148:151], v[232:235]
    v_mfma_f32_16x16x32_bf16 v[216:219], v[64:67], v[144:147], v[216:219]
    v_mfma_f32_16x16x32_bf16 v[236:239], v[64:67], v[148:151], v[236:239]
    s_mov_b32 s6, 20480
    buffer_load_dwordx4 v[144:147], v7, s[56:59], s6 offen offset:2048 sc1
    buffer_load_dwordx4 v[148:151], v75, s[56:59], s6 offen offset:2048 sc1
    s_barrier
    s_waitcnt vmcnt(14) lgkmcnt(0)
    ds_read_b128 v[48:51], v72 offset:12288
    v_mfma_f32_16x16x32_bf16 v[200:203], v[24:27], v[152:155], v[200:203]
    ds_read_b128 v[52:55], v72 offset:13312
    v_mfma_f32_16x16x32_bf16 v[220:223], v[24:27], v[156:159], v[220:223]
    ds_read_b128 v[56:59], v72 offset:14336
    v_mfma_f32_16x16x32_bf16 v[204:207], v[28:31], v[152:155], v[204:207]
    ds_read_b128 v[60:63], v72 offset:15360
    v_mfma_f32_16x16x32_bf16 v[224:227], v[28:31], v[156:159], v[224:227]
    ds_read_b128 v[64:67], v72 offset:16384
    v_mfma_f32_16x16x32_bf16 v[208:211], v[32:35], v[152:155], v[208:211]
    v_mfma_f32_16x16x32_bf16 v[228:231], v[32:35], v[156:159], v[228:231]
    v_mfma_f32_16x16x32_bf16 v[212:215], v[36:39], v[152:155], v[212:215]
    v_mfma_f32_16x16x32_bf16 v[232:235], v[36:39], v[156:159], v[232:235]
    v_mfma_f32_16x16x32_bf16 v[216:219], v[40:43], v[152:155], v[216:219]
    v_mfma_f32_16x16x32_bf16 v[236:239], v[40:43], v[156:159], v[236:239]
    s_mov_b32 s6, 24576
    buffer_load_dwordx4 v[152:155], v7, s[56:59], s6 offen offset:0 sc1
    buffer_load_dwordx4 v[156:159], v75, s[56:59], s6 offen offset:0 sc1
    s_waitcnt vmcnt(14) lgkmcnt(0)
    ds_read_b128 v[24:27], v72 offset:24576
    v_mfma_f32_16x16x32_bf16 v[200:203], v[48:51], v[160:163], v[200:203]
    ds_read_b128 v[28:31], v72 offset:25600
    v_mfma_f32_16x16x32_bf16 v[220:223], v[48:51], v[164:167], v[220:223]
    ds_read_b128 v[32:35], v72 offset:26624
    v_mfma_f32_16x16x32_bf16 v[204:207], v[52:55], v[160:163], v[204:207]
    ds_read_b128 v[36:39], v72 offset:27648
    v_mfma_f32_16x16x32_bf16 v[224:227], v[52:55], v[164:167], v[224:227]
    ds_read_b128 v[40:43], v72 offset:28672
    v_mfma_f32_16x16x32_bf16 v[208:211], v[56:59], v[160:163], v[208:211]
    v_mfma_f32_16x16x32_bf16 v[228:231], v[56:59], v[164:167], v[228:231]
    v_mfma_f32_16x16x32_bf16 v[212:215], v[60:63], v[160:163], v[212:215]
    v_mfma_f32_16x16x32_bf16 v[232:235], v[60:63], v[164:167], v[232:235]
    v_mfma_f32_16x16x32_bf16 v[216:219], v[64:67], v[160:163], v[216:219]
    v_mfma_f32_16x16x32_bf16 v[236:239], v[64:67], v[164:167], v[236:239]
    s_mov_b32 s6, 24576
    buffer_load_dwordx4 v[160:163], v7, s[56:59], s6 offen offset:2048 sc1
    buffer_load_dwordx4 v[164:167], v75, s[56:59], s6 offen offset:2048 sc1
    s_waitcnt vmcnt(14) lgkmcnt(0)
    ds_read_b128 v[48:51], v72 offset:36864
    v_mfma_f32_16x16x32_bf16 v[200:203], v[24:27], v[168:171], v[200:203]
    ds_read_b128 v[52:55], v72 offset:37888
    v_mfma_f32_16x16x32_bf16 v[220:223], v[24:27], v[172:175], v[220:223]
    ds_read_b128 v[56:59], v72 offset:38912
    v_mfma_f32_16x16x32_bf16 v[204:207], v[28:31], v[168:171], v[204:207]
    ds_read_b128 v[60:63], v72 offset:39936
    v_mfma_f32_16x16x32_bf16 v[224:227], v[28:31], v[172:175], v[224:227]
    ds_read_b128 v[64:67], v72 offset:40960
    v_mfma_f32_16x16x32_bf16 v[208:211], v[32:35], v[168:171], v[208:211]
    v_mfma_f32_16x16x32_bf16 v[228:231], v[32:35], v[172:175], v[228:231]
    v_mfma_f32_16x16x32_bf16 v[212:215], v[36:39], v[168:171], v[212:215]
    v_mfma_f32_16x16x32_bf16 v[232:235], v[36:39], v[172:175], v[232:235]
    v_mfma_f32_16x16x32_bf16 v[216:219], v[40:43], v[168:171], v[216:219]
    v_mfma_f32_16x16x32_bf16 v[236:239], v[40:43], v[172:175], v[236:239]
    s_mov_b32 s6, 28672
    buffer_load_dwordx4 v[168:171], v7, s[56:59], s6 offen offset:0 sc1
    buffer_load_dwordx4 v[172:175], v75, s[56:59], s6 offen offset:0 sc1
    s_waitcnt vmcnt(14) lgkmcnt(0)
    ds_read_b128 v[24:27], v73 offset:0
    v_mfma_f32_16x16x32_bf16 v[200:203], v[48:51], v[176:179], v[200:203]
    ds_read_b128 v[28:31], v73 offset:1024
    v_mfma_f32_16x16x32_bf16 v[220:223], v[48:51], v[180:183], v[220:223]
    ds_read_b128 v[32:35], v73 offset:2048
    v_mfma_f32_16x16x32_bf16 v[204:207], v[52:55], v[176:179], v[204:207]
    ds_read_b128 v[36:39], v73 offset:3072
    v_mfma_f32_16x16x32_bf16 v[224:227], v[52:55], v[180:183], v[224:227]
    ds_read_b128 v[40:43], v73 offset:4096
    v_mfma_f32_16x16x32_bf16 v[208:211], v[56:59], v[176:179], v[208:211]
    v_mfma_f32_16x16x32_bf16 v[228:231], v[56:59], v[180:183], v[228:231]
    v_mfma_f32_16x16x32_bf16 v[212:215], v[60:63], v[176:179], v[212:215]
    v_mfma_f32_16x16x32_bf16 v[232:235], v[60:63], v[180:183], v[232:235]
    v_mfma_f32_16x16x32_bf16 v[216:219], v[64:67], v[176:179], v[216:219]
    v_mfma_f32_16x16x32_bf16 v[236:239], v[64:67], v[180:183], v[236:239]
    s_mov_b32 s6, 28672
    buffer_load_dwordx4 v[176:179], v7, s[56:59], s6 offen offset:2048 sc1
    buffer_load_dwordx4 v[180:183], v75, s[56:59], s6 offen offset:2048 sc1
    s_barrier
    s_waitcnt vmcnt(14) lgkmcnt(0)
    ds_read_b128 v[48:51], v73 offset:12288
    v_mfma_f32_16x16x32_bf16 v[200:203], v[24:27], v[120:123], v[200:203]
    ds_read_b128 v[52:55], v73 offset:13312
    v_mfma_f32_16x16x32_bf16 v[220:223], v[24:27], v[124:127], v[220:223]
    ds_read_b128 v[56:59], v73 offset:14336
    v_mfma_f32_16x16x32_bf16 v[204:207], v[28:31], v[120:123], v[204:207]
    ds_read_b128 v[60:63], v73 offset:15360
    v_mfma_f32_16x16x32_bf16 v[224:227], v[28:31], v[124:127], v[224:227]
    ds_read_b128 v[64:67], v73 offset:16384
    v_mfma_f32_16x16x32_bf16 v[208:211], v[32:35], v[120:123], v[208:211]
    v_mfma_f32_16x16x32_bf16 v[228:231], v[32:35], v[124:127], v[228:231]
    v_mfma_f32_16x16x32_bf16 v[212:215], v[36:39], v[120:123], v[212:215]
    v_mfma_f32_16x16x32_bf16 v[232:235], v[36:39], v[124:127], v[232:235]
    v_mfma_f32_16x16x32_bf16 v[216:219], v[40:43], v[120:123], v[216:219]
    v_mfma_f32_16x16x32_bf16 v[236:239], v[40:43], v[124:127], v[236:239]
    s_mov_b32 s6, 32768
    buffer_load_dwordx4 v[120:123], v7, s[56:59], s6 offen offset:0 sc1
    buffer_load_dwordx4 v[124:127], v75, s[56:59], s6 offen offset:0 sc1
    s_waitcnt vmcnt(14) lgkmcnt(0)
    ds_read_b128 v[24:27], v73 offset:24576
    v_mfma_f32_16x16x32_bf16 v[200:203], v[48:51], v[128:131], v[200:203]
    ds_read_b128 v[28:31], v73 offset:25600
    v_mfma_f32_16x16x32_bf16 v[220:223], v[48:51], v[132:135], v[220:223]
    ds_read_b128 v[32:35], v73 offset:26624
    v_mfma_f32_16x16x32_bf16 v[204:207], v[52:55], v[128:131], v[204:207]
    ds_read_b128 v[36:39], v73 offset:27648
    v_mfma_f32_16x16x32_bf16 v[224:227], v[52:55], v[132:135], v[224:227]
    ds_read_b128 v[40:43], v73 offset:28672
    v_mfma_f32_16x16x32_bf16 v[208:211], v[56:59], v[128:131], v[208:211]
    v_mfma_f32_16x16x32_bf16 v[228:231], v[56:59], v[132:135], v[228:231]
    v_mfma_f32_16x16x32_bf16 v[212:215], v[60:63], v[128:131], v[212:215]
    v_mfma_f32_16x16x32_bf16 v[232:235], v[60:63], v[132:135], v[232:235]
    v_mfma_f32_16x16x32_bf16 v[216:219], v[64:67], v[128:131], v[216:219]
    v_mfma_f32_16x16x32_bf16 v[236:239], v[64:67], v[132:135], v[236:239]
    s_mov_b32 s6, 32768
    buffer_load_dwordx4 v[128:131], v7, s[56:59], s6 offen offset:2048 sc1
    buffer_load_dwordx4 v[132:135], v75, s[56:59], s6 offen offset:2048 sc1
    s_waitcnt vmcnt(14) lgkmcnt(0)
    ds_read_b128 v[48:51], v73 offset:36864
    v_mfma_f32_16x16x32_bf16 v[200:203], v[24:27], v[136:139], v[200:203]
    ds_read_b128 v[52:55], v73 offset:37888
    v_mfma_f32_16x16x32_bf16 v[220:223], v[24:27], v[140:143], v[220:223]
    ds_read_b128 v[56:59], v73 offset:38912
    v_mfma_f32_16x16x32_bf16 v[204:207], v[28:31], v[136:139], v[204:207]
    ds_read_b128 v[60:63], v73 offset:39936
    v_mfma_f32_16x16x32_bf16 v[224:227], v[28:31], v[140:143], v[224:227]
    ds_read_b128 v[64:67], v73 offset:40960
    v_mfma_f32_16x16x32_bf16 v[208:211], v[32:35], v[136:139], v[208:211]
    v_mfma_f32_16x16x32_bf16 v[228:231], v[32:35], v[140:143], v[228:231]
    v_mfma_f32_16x16x32_bf16 v[212:215], v[36:39], v[136:139], v[212:215]
    v_mfma_f32_16x16x32_bf16 v[232:235], v[36:39], v[140:143], v[232:235]
    v_mfma_f32_16x16x32_bf16 v[216:219], v[40:43], v[136:139], v[216:219]
    v_mfma_f32_16x16x32_bf16 v[236:239], v[40:43], v[140:143], v[236:239]
    s_mov_b32 s6, 36864
    buffer_load_dwordx4 v[136:139], v7, s[56:59], s6 offen offset:0 sc1
    buffer_load_dwordx4 v[140:143], v75, s[56:59], s6 offen offset:0 sc1
    s_waitcnt vmcnt(14) lgkmcnt(0)
    ds_read_b128 v[24:27], v74 offset:0
    v_mfma_f32_16x16x32_bf16 v[200:203], v[48:51], v[144:147], v[200:203]
    ds_read_b128 v[28:31], v74 offset:1024
    v_mfma_f32_16x16x32_bf16 v[220:223], v[48:51], v[148:151], v[220:223]
    ds_read_b128 v[32:35], v74 offset:2048
    v_mfma_f32_16x16x32_bf16 v[204:207], v[52:55], v[144:147], v[204:207]
    ds_read_b128 v[36:39], v74 offset:3072
    v_mfma_f32_16x16x32_bf16 v[224:227], v[52:55], v[148:151], v[224:227]
    ds_read_b128 v[40:43], v74 offset:4096
    v_mfma_f32_16x16x32_bf16 v[208:211], v[56:59], v[144:147], v[208:211]
    v_mfma_f32_16x16x32_bf16 v[228:231], v[56:59], v[148:151], v[228:231]
    v_mfma_f32_16x16x32_bf16 v[212:215], v[60:63], v[144:147], v[212:215]
    v_mfma_f32_16x16x32_bf16 v[232:235], v[60:63], v[148:151], v[232:235]
    v_mfma_f32_16x16x32_bf16 v[216:219], v[64:67], v[144:147], v[216:219]
    v_mfma_f32_16x16x32_bf16 v[236:239], v[64:67], v[148:151], v[236:239]
    s_mov_b32 s6, 36864
    buffer_load_dwordx4 v[144:147], v7, s[56:59], s6 offen offset:2048 sc1
    buffer_load_dwordx4 v[148:151], v75, s[56:59], s6 offen offset:2048 sc1
    s_barrier
    s_waitcnt vmcnt(14) lgkmcnt(0)
    ds_read_b128 v[48:51], v74 offset:12288
    v_mfma_f32_16x16x32_bf16 v[200:203], v[24:27], v[152:155], v[200:203]
    ds_read_b128 v[52:55], v74 offset:13312
    v_mfma_f32_16x16x32_bf16 v[220:223], v[24:27], v[156:159], v[220:223]
    ds_read_b128 v[56:59], v74 offset:14336
    v_mfma_f32_16x16x32_bf16 v[204:207], v[28:31], v[152:155], v[204:207]
    ds_read_b128 v[60:63], v74 offset:15360
    v_mfma_f32_16x16x32_bf16 v[224:227], v[28:31], v[156:159], v[224:227]
    ds_read_b128 v[64:67], v74 offset:16384
    v_mfma_f32_16x16x32_bf16 v[208:211], v[32:35], v[152:155], v[208:211]
    v_mfma_f32_16x16x32_bf16 v[228:231], v[32:35], v[156:159], v[228:231]
    v_mfma_f32_16x16x32_bf16 v[212:215], v[36:39], v[152:155], v[212:215]
    v_mfma_f32_16x16x32_bf16 v[232:235], v[36:39], v[156:159], v[232:235]
    v_mfma_f32_16x16x32_bf16 v[216:219], v[40:43], v[152:155], v[216:219]
    v_mfma_f32_16x16x32_bf16 v[236:239], v[40:43], v[156:159], v[236:239]
    s_mov_b32 s6, 40960
    buffer_load_dwordx4 v[152:155], v7, s[56:59], s6 offen offset:0 sc1
    buffer_load_dwordx4 v[156:159], v75, s[56:59], s6 offen offset:0 sc1
    s_waitcnt vmcnt(14) lgkmcnt(0)
    ds_read_b128 v[24:27], v74 offset:24576
    v_mfma_f32_16x16x32_bf16 v[200:203], v[48:51], v[160:163], v[200:203]
    ds_read_b128 v[28:31], v74 offset:25600
    v_mfma_f32_16x16x32_bf16 v[220:223], v[48:51], v[164:167], v[220:223]
    ds_read_b128 v[32:35], v74 offset:26624
    v_mfma_f32_16x16x32_bf16 v[204:207], v[52:55], v[160:163], v[204:207]
    ds_read_b128 v[36:39], v74 offset:27648
    v_mfma_f32_16x16x32_bf16 v[224:227], v[52:55], v[164:167], v[224:227]
    ds_read_b128 v[40:43], v74 offset:28672
    v_mfma_f32_16x16x32_bf16 v[208:211], v[56:59], v[160:163], v[208:211]
    v_mfma_f32_16x16x32_bf16 v[228:231], v[56:59], v[164:167], v[228:231]
    v_mfma_f32_16x16x32_bf16 v[212:215], v[60:63], v[160:163], v[212:215]
    v_mfma_f32_16x16x32_bf16 v[232:235], v[60:63], v[164:167], v[232:235]
    v_mfma_f32_16x16x32_bf16 v[216:219], v[64:67], v[160:163], v[216:219]
    v_mfma_f32_16x16x32_bf16 v[236:239], v[64:67], v[164:167], v[236:239]
    s_mov_b32 s6, 40960
    buffer_load_dwordx4 v[160:163], v7, s[56:59], s6 offen offset:2048 sc1
    buffer_load_dwordx4 v[164:167], v75, s[56:59], s6 offen offset:2048 sc1
    s_waitcnt vmcnt(14) lgkmcnt(0)
    ds_read_b128 v[48:51], v74 offset:36864
    v_mfma_f32_16x16x32_bf16 v[200:203], v[24:27], v[168:171], v[200:203]
    ds_read_b128 v[52:55], v74 offset:37888
    v_mfma_f32_16x16x32_bf16 v[220:223], v[24:27], v[172:175], v[220:223]
    ds_read_b128 v[56:59], v74 offset:38912
    v_mfma_f32_16x16x32_bf16 v[204:207], v[28:31], v[168:171], v[204:207]
    ds_read_b128 v[60:63], v74 offset:39936
    v_mfma_f32_16x16x32_bf16 v[224:227], v[28:31], v[172:175], v[224:227]
    ds_read_b128 v[64:67], v74 offset:40960
    v_mfma_f32_16x16x32_bf16 v[208:211], v[32:35], v[168:171], v[208:211]
    v_mfma_f32_16x16x32_bf16 v[228:231], v[32:35], v[172:175], v[228:231]
    v_mfma_f32_16x16x32_bf16 v[212:215], v[36:39], v[168:171], v[212:215]
    v_mfma_f32_16x16x32_bf16 v[232:235], v[36:39], v[172:175], v[232:235]
    v_mfma_f32_16x16x32_bf16 v[216:219], v[40:43], v[168:171], v[216:219]
    v_mfma_f32_16x16x32_bf16 v[236:239], v[40:43], v[172:175], v[236:239]
    s_mov_b32 s6, 45056
    buffer_load_dwordx4 v[168:171], v7, s[56:59], s6 offen offset:0 sc1
    buffer_load_dwordx4 v[172:175], v75, s[56:59], s6 offen offset:0 sc1
    s_waitcnt vmcnt(14) lgkmcnt(0)
    ds_read_b128 v[24:27], v72 offset:0
    v_mfma_f32_16x16x32_bf16 v[200:203], v[48:51], v[176:179], v[200:203]
    ds_read_b128 v[28:31], v72 offset:1024
    v_mfma_f32_16x16x32_bf16 v[220:223], v[48:51], v[180:183], v[220:223]
    ds_read_b128 v[32:35], v72 offset:2048
    v_mfma_f32_16x16x32_bf16 v[204:207], v[52:55], v[176:179], v[204:207]
    ds_read_b128 v[36:39], v72 offset:3072
    v_mfma_f32_16x16x32_bf16 v[224:227], v[52:55], v[180:183], v[224:227]
    ds_read_b128 v[40:43], v72 offset:4096
    v_mfma_f32_16x16x32_bf16 v[208:211], v[56:59], v[176:179], v[208:211]
    v_mfma_f32_16x16x32_bf16 v[228:231], v[56:59], v[180:183], v[228:231]
    v_mfma_f32_16x16x32_bf16 v[212:215], v[60:63], v[176:179], v[212:215]
    v_mfma_f32_16x16x32_bf16 v[232:235], v[60:63], v[180:183], v[232:235]
    v_mfma_f32_16x16x32_bf16 v[216:219], v[64:67], v[176:179], v[216:219]
    v_mfma_f32_16x16x32_bf16 v[236:239], v[64:67], v[180:183], v[236:239]
    s_mov_b32 s6, 45056
    buffer_load_dwordx4 v[176:179], v7, s[56:59], s6 offen offset:2048 sc1
    buffer_load_dwordx4 v[180:183], v75, s[56:59], s6 offen offset:2048 sc1
    s_barrier
    s_waitcnt vmcnt(14) lgkmcnt(0)
    ds_read_b128 v[48:51], v72 offset:12288
    v_mfma_f32_16x16x32_bf16 v[200:203], v[24:27], v[120:123], v[200:203]
    ds_read_b128 v[52:55], v72 offset:13312
    v_mfma_f32_16x16x32_bf16 v[220:223], v[24:27], v[124:127], v[220:223]
    ds_read_b128 v[56:59], v72 offset:14336
    v_mfma_f32_16x16x32_bf16 v[204:207], v[28:31], v[120:123], v[204:207]
    ds_read_b128 v[60:63], v72 offset:15360
    v_mfma_f32_16x16x32_bf16 v[224:227], v[28:31], v[124:127], v[224:227]
    ds_read_b128 v[64:67], v72 offset:16384
    v_mfma_f32_16x16x32_bf16 v[208:211], v[32:35], v[120:123], v[208:211]
    v_mfma_f32_16x16x32_bf16 v[228:231], v[32:35], v[124:127], v[228:231]
    v_mfma_f32_16x16x32_bf16 v[212:215], v[36:39], v[120:123], v[212:215]
    v_mfma_f32_16x16x32_bf16 v[232:235], v[36:39], v[124:127], v[232:235]
    v_mfma_f32_16x16x32_bf16 v[216:219], v[40:43], v[120:123], v[216:219]
    v_mfma_f32_16x16x32_bf16 v[236:239], v[40:43], v[124:127], v[236:239]
    s_waitcnt vmcnt(12) lgkmcnt(0)
    ds_read_b128 v[24:27], v72 offset:24576
    v_mfma_f32_16x16x32_bf16 v[200:203], v[48:51], v[128:131], v[200:203]
    ds_read_b128 v[28:31], v72 offset:25600
    v_mfma_f32_16x16x32_bf16 v[220:223], v[48:51], v[132:135], v[220:223]
    ds_read_b128 v[32:35], v72 offset:26624
    v_mfma_f32_16x16x32_bf16 v[204:207], v[52:55], v[128:131], v[204:207]
    ds_read_b128 v[36:39], v72 offset:27648
    v_mfma_f32_16x16x32_bf16 v[224:227], v[52:55], v[132:135], v[224:227]
    ds_read_b128 v[40:43], v72 offset:28672
    v_mfma_f32_16x16x32_bf16 v[208:211], v[56:59], v[128:131], v[208:211]
    v_mfma_f32_16x16x32_bf16 v[228:231], v[56:59], v[132:135], v[228:231]
    v_mfma_f32_16x16x32_bf16 v[212:215], v[60:63], v[128:131], v[212:215]
    v_mfma_f32_16x16x32_bf16 v[232:235], v[60:63], v[132:135], v[232:235]
    v_mfma_f32_16x16x32_bf16 v[216:219], v[64:67], v[128:131], v[216:219]
    v_mfma_f32_16x16x32_bf16 v[236:239], v[64:67], v[132:135], v[236:239]
    s_waitcnt vmcnt(10) lgkmcnt(0)
    ds_read_b128 v[48:51], v72 offset:36864
    v_mfma_f32_16x16x32_bf16 v[200:203], v[24:27], v[136:139], v[200:203]
    ds_read_b128 v[52:55], v72 offset:37888
    v_mfma_f32_16x16x32_bf16 v[220:223], v[24:27], v[140:143], v[220:223]
    ds_read_b128 v[56:59], v72 offset:38912
    v_mfma_f32_16x16x32_bf16 v[204:207], v[28:31], v[136:139], v[204:207]
    ds_read_b128 v[60:63], v72 offset:39936
    v_mfma_f32_16x16x32_bf16 v[224:227], v[28:31], v[140:143], v[224:227]
    ds_read_b128 v[64:67], v72 offset:40960
    v_mfma_f32_16x16x32_bf16 v[208:211], v[32:35], v[136:139], v[208:211]
    v_mfma_f32_16x16x32_bf16 v[228:231], v[32:35], v[140:143], v[228:231]
    v_mfma_f32_16x16x32_bf16 v[212:215], v[36:39], v[136:139], v[212:215]
    v_mfma_f32_16x16x32_bf16 v[232:235], v[36:39], v[140:143], v[232:235]
    v_mfma_f32_16x16x32_bf16 v[216:219], v[40:43], v[136:139], v[216:219]
    v_mfma_f32_16x16x32_bf16 v[236:239], v[40:43], v[140:143], v[236:239]
    s_waitcnt vmcnt(8) lgkmcnt(0)
    ds_read_b128 v[24:27], v73 offset:0
    v_mfma_f32_16x16x32_bf16 v[200:203], v[48:51], v[144:147], v[200:203]
    ds_read_b128 v[28:31], v73 offset:1024
    v_mfma_f32_16x16x32_bf16 v[220:223], v[48:51], v[148:151], v[220:223]
    ds_read_b128 v[32:35], v73 offset:2048
    v_mfma_f32_16x16x32_bf16 v[204:207], v[52:55], v[144:147], v[204:207]
    ds_read_b128 v[36:39], v73 offset:3072
    v_mfma_f32_16x16x32_bf16 v[224:227], v[52:55], v[148:151], v[224:227]
    ds_read_b128 v[40:43], v73 offset:4096
    v_mfma_f32_16x16x32_bf16 v[208:211], v[56:59], v[144:147], v[208:211]
    v_mfma_f32_16x16x32_bf16 v[228:231], v[56:59], v[148:151], v[228:231]
    v_mfma_f32_16x16x32_bf16 v[212:215], v[60:63], v[144:147], v[212:215]
    v_mfma_f32_16x16x32_bf16 v[232:235], v[60:63], v[148:151], v[232:235]
    v_mfma_f32_16x16x32_bf16 v[216:219], v[64:67], v[144:147], v[216:219]
    v_mfma_f32_16x16x32_bf16 v[236:239], v[64:67], v[148:151], v[236:239]
    s_barrier
    s_waitcnt vmcnt(6) lgkmcnt(0)
    ds_read_b128 v[48:51], v73 offset:12288
    v_mfma_f32_16x16x32_bf16 v[200:203], v[24:27], v[152:155], v[200:203]
    ds_read_b128 v[52:55], v73 offset:13312
    v_mfma_f32_16x16x32_bf16 v[220:223], v[24:27], v[156:159], v[220:223]
    ds_read_b128 v[56:59], v73 offset:14336
    v_mfma_f32_16x16x32_bf16 v[204:207], v[28:31], v[152:155], v[204:207]
    ds_read_b128 v[60:63], v73 offset:15360
    v_mfma_f32_16x16x32_bf16 v[224:227], v[28:31], v[156:159], v[224:227]
    ds_read_b128 v[64:67], v73 offset:16384
    v_mfma_f32_16x16x32_bf16 v[208:211], v[32:35], v[152:155], v[208:211]
    v_mfma_f32_16x16x32_bf16 v[228:231], v[32:35], v[156:159], v[228:231]
    v_mfma_f32_16x16x32_bf16 v[212:215], v[36:39], v[152:155], v[212:215]
    v_mfma_f32_16x16x32_bf16 v[232:235], v[36:39], v[156:159], v[232:235]
    v_mfma_f32_16x16x32_bf16 v[216:219], v[40:43], v[152:155], v[216:219]
    v_mfma_f32_16x16x32_bf16 v[236:239], v[40:43], v[156:159], v[236:239]
    s_waitcnt vmcnt(4) lgkmcnt(0)
    ds_read_b128 v[24:27], v73 offset:24576
    v_mfma_f32_16x16x32_bf16 v[200:203], v[48:51], v[160:163], v[200:203]
    ds_read_b128 v[28:31], v73 offset:25600
    v_mfma_f32_16x16x32_bf16 v[220:223], v[48:51], v[164:167], v[220:223]
    ds_read_b128 v[32:35], v73 offset:26624
    v_mfma_f32_16x16x32_bf16 v[204:207], v[52:55], v[160:163], v[204:207]
    ds_read_b128 v[36:39], v73 offset:27648
    v_mfma_f32_16x16x32_bf16 v[224:227], v[52:55], v[164:167], v[224:227]
    ds_read_b128 v[40:43], v73 offset:28672
    v_mfma_f32_16x16x32_bf16 v[208:211], v[56:59], v[160:163], v[208:211]
    v_mfma_f32_16x16x32_bf16 v[228:231], v[56:59], v[164:167], v[228:231]
    v_mfma_f32_16x16x32_bf16 v[212:215], v[60:63], v[160:163], v[212:215]
    v_mfma_f32_16x16x32_bf16 v[232:235], v[60:63], v[164:167], v[232:235]
    v_mfma_f32_16x16x32_bf16 v[216:219], v[64:67], v[160:163], v[216:219]
    v_mfma_f32_16x16x32_bf16 v[236:239], v[64:67], v[164:167], v[236:239]
    s_waitcnt vmcnt(2) lgkmcnt(0)
    ds_read_b128 v[48:51], v73 offset:36864
    v_mfma_f32_16x16x32_bf16 v[200:203], v[24:27], v[168:171], v[200:203]
    ds_read_b128 v[52:55], v73 offset:37888
    v_mfma_f32_16x16x32_bf16 v[220:223], v[24:27], v[172:175], v[220:223]
    ds_read_b128 v[56:59], v73 offset:38912
    v_mfma_f32_16x16x32_bf16 v[204:207], v[28:31], v[168:171], v[204:207]
    ds_read_b128 v[60:63], v73 offset:39936
    v_mfma_f32_16x16x32_bf16 v[224:227], v[28:31], v[172:175], v[224:227]
    ds_read_b128 v[64:67], v73 offset:40960
    v_mfma_f32_16x16x32_bf16 v[208:211], v[32:35], v[168:171], v[208:211]
    v_mfma_f32_16x16x32_bf16 v[228:231], v[32:35], v[172:175], v[228:231]
    v_mfma_f32_16x16x32_bf16 v[212:215], v[36:39], v[168:171], v[212:215]
    v_mfma_f32_16x16x32_bf16 v[232:235], v[36:39], v[172:175], v[232:235]
    v_mfma_f32_16x16x32_bf16 v[216:219], v[40:43], v[168:171], v[216:219]
    v_mfma_f32_16x16x32_bf16 v[236:239], v[40:43], v[172:175], v[236:239]
    s_waitcnt vmcnt(0) lgkmcnt(0)
    v_mfma_f32_16x16x32_bf16 v[200:203], v[48:51], v[176:179], v[200:203]
    v_mfma_f32_16x16x32_bf16 v[220:223], v[48:51], v[180:183], v[220:223]
    v_mfma_f32_16x16x32_bf16 v[204:207], v[52:55], v[176:179], v[204:207]
    v_mfma_f32_16x16x32_bf16 v[224:227], v[52:55], v[180:183], v[224:227]
    v_mfma_f32_16x16x32_bf16 v[208:211], v[56:59], v[176:179], v[208:211]
    v_mfma_f32_16x16x32_bf16 v[228:231], v[56:59], v[180:183], v[228:231]
    v_mfma_f32_16x16x32_bf16 v[212:215], v[60:63], v[176:179], v[212:215]
    v_mfma_f32_16x16x32_bf16 v[232:235], v[60:63], v[180:183], v[232:235]
    v_mfma_f32_16x16x32_bf16 v[216:219], v[64:67], v[176:179], v[216:219]
    v_mfma_f32_16x16x32_bf16 v[236:239], v[64:67], v[180:183], v[236:239]
    s_nop 7
    ds_write_b128 v76, v[220:223] offset:0
    ds_write_b128 v76, v[224:227] offset:4096
    ds_write_b128 v76, v[228:231] offset:8192
    ds_write_b128 v76, v[232:235] offset:12288
    ds_write_b128 v77, v[236:239] offset:0
    s_waitcnt lgkmcnt(0)
    s_barrier
    ds_read_b128 v[24:27], v78 offset:0
    ds_read_b128 v[28:31], v78 offset:4096
    ds_read_b128 v[32:35], v78 offset:8192
    ds_read_b128 v[36:39], v78 offset:12288
    ds_read_b128 v[40:43], v79 offset:0
    s_waitcnt lgkmcnt(4)
    v_pk_add_f32 v[200:201], v[200:201], v[24:25]
    v_pk_add_f32 v[202:203], v[202:203], v[26:27]
    s_waitcnt lgkmcnt(3)
    v_pk_add_f32 v[204:205], v[204:205], v[28:29]
    v_pk_add_f32 v[206:207], v[206:207], v[30:31]
    s_waitcnt lgkmcnt(2)
    v_pk_add_f32 v[208:209], v[208:209], v[32:33]
    v_pk_add_f32 v[210:211], v[210:211], v[34:35]
    s_waitcnt lgkmcnt(1)
    v_pk_add_f32 v[212:213], v[212:213], v[36:37]
    v_pk_add_f32 v[214:215], v[214:215], v[38:39]
    s_waitcnt lgkmcnt(0)
    v_pk_add_f32 v[216:217], v[216:217], v[40:41]
    v_pk_add_f32 v[218:219], v[218:219], v[42:43]
    v_cvt_pk_bf16_f32 v200, v200, v201
    v_cvt_pk_bf16_f32 v201, v202, v203
    buffer_store_dwordx2 v[200:201], v11, s[44:47], 0 offen offset:0
    v_cvt_pk_bf16_f32 v204, v204, v205
    v_cvt_pk_bf16_f32 v205, v206, v207
    buffer_store_dwordx2 v[204:205], v11, s[44:47], 0 offen offset:32
    v_cvt_pk_bf16_f32 v208, v208, v209
    v_cvt_pk_bf16_f32 v209, v210, v211
    buffer_store_dwordx2 v[208:209], v11, s[44:47], 0 offen offset:64
    v_cvt_pk_bf16_f32 v212, v212, v213
    v_cvt_pk_bf16_f32 v213, v214, v215
    buffer_store_dwordx2 v[212:213], v11, s[44:47], 0 offen offset:96
    v_cvt_pk_bf16_f32 v216, v216, v217
    v_cvt_pk_bf16_f32 v217, v218, v219
    buffer_store_dwordx2 v[216:217], v11, s[44:47], 0 offen offset:128
sequential_preLN__grouped_kv_mqa__dense_activation_squared_relu__prompt_kernel_end:
    s_endpgm
sequential_preLN__grouped_kv_mqa__dense_activation_squared_relu__prompt_kernel_loader:
    s_add_u32 m0, s98, 73728
    s_mov_b32 s99, 61440
    buffer_load_dwordx4 v252, s[68:71], s99 offen offset:0 sc1 lds
    buffer_load_dwordx4 v252, s[68:71], s99 offen offset:1024 sc1 lds
    buffer_load_dwordx4 v252, s[68:71], s99 offen offset:2048 sc1 lds
    buffer_load_dwordx4 v252, s[68:71], s99 offen offset:3072 sc1 lds
    s_add_u32 m0, m0, 0x1000
    s_nop 0
    buffer_load_dwordx4 v253, s[68:71], s99 offen offset:0 sc1 lds
    s_add_u32 m0, s98, 98304
    s_mov_b32 s99, 81920
    buffer_load_dwordx4 v252, s[68:71], s99 offen offset:0 sc1 lds
    buffer_load_dwordx4 v252, s[68:71], s99 offen offset:1024 sc1 lds
    buffer_load_dwordx4 v252, s[68:71], s99 offen offset:2048 sc1 lds
    buffer_load_dwordx4 v252, s[68:71], s99 offen offset:3072 sc1 lds
    s_add_u32 m0, m0, 0x1000
    s_nop 0
    buffer_load_dwordx4 v253, s[68:71], s99 offen offset:0 sc1 lds
    s_sub_u32 s6, s3, 4
    s_mul_i32 s6, s6, 3072
    v_lshlrev_b32 v8, 4, v1
    v_add_u32 v4, s6, v8
    v_add_u32 v5, 49152, v4
    v_add_u32 v6, 98304, v4
    s_sub_u32 s99, s3, 4
    s_mul_i32 s6, s5, 245760
    s_mul_i32 s98, s99, 5120
    s_add_u32 s6, s6, s98
    s_add_u32 s6, s6, 2785280
    v_add_u32 v252, s6, v8
    v_add_u32 v253, 0x1000, v252
    s_lshr_b32 s98, s99, 1
    s_mul_i32 s98, s98, 12288
    s_and_b32 s99, s99, 1
    s_mul_i32 s99, s99, 5120
    s_add_u32 s98, s98, s99
    v_add_u32 v9, s98, v8
    v_add_u32 v10, 49152, v9
    v_add_u32 v11, 98304, v9
    s_barrier
    ds_write_b128 v6, v[132:135] offset:24576
    ds_write_b128 v6, v[136:139] offset:25600
    ds_write_b128 v6, v[140:143] offset:26624
    ds_write_b128 v6, v[144:147] offset:36864
    ds_write_b128 v6, v[148:151] offset:37888
    ds_write_b128 v6, v[152:155] offset:38912
    s_mov_b32 s99, 102400
    buffer_load_dwordx4 v[12:15], v252, s[68:71], s99 offen offset:0 sc1
    buffer_load_dwordx4 v[16:19], v252, s[68:71], s99 offen offset:1024 sc1
    buffer_load_dwordx4 v[20:23], v252, s[68:71], s99 offen offset:2048 sc1
    buffer_load_dwordx4 v[24:27], v252, s[68:71], s99 offen offset:3072 sc1
    buffer_load_dwordx4 v[28:31], v253, s[68:71], s99 offen offset:0 sc1
    s_mov_b32 s99, 122880
    buffer_load_dwordx4 v[32:35], v252, s[68:71], s99 offen offset:0 sc1
    buffer_load_dwordx4 v[36:39], v252, s[68:71], s99 offen offset:1024 sc1
    buffer_load_dwordx4 v[40:43], v252, s[68:71], s99 offen offset:2048 sc1
    buffer_load_dwordx4 v[44:47], v252, s[68:71], s99 offen offset:3072 sc1
    buffer_load_dwordx4 v[48:51], v253, s[68:71], s99 offen offset:0 sc1
    s_mov_b32 s99, 143360
    buffer_load_dwordx4 v[52:55], v252, s[68:71], s99 offen offset:0 sc1
    buffer_load_dwordx4 v[56:59], v252, s[68:71], s99 offen offset:1024 sc1
    buffer_load_dwordx4 v[60:63], v252, s[68:71], s99 offen offset:2048 sc1
    buffer_load_dwordx4 v[64:67], v252, s[68:71], s99 offen offset:3072 sc1
    buffer_load_dwordx4 v[68:71], v253, s[68:71], s99 offen offset:0 sc1
    s_waitcnt vmcnt(15)
    s_barrier
    ds_write_b128 v4, v[156:159] offset:0
    ds_write_b128 v4, v[160:163] offset:1024
    ds_write_b128 v4, v[164:167] offset:2048
    ds_write_b128 v4, v[168:171] offset:12288
    ds_write_b128 v4, v[172:175] offset:13312
    ds_write_b128 v4, v[176:179] offset:14336
    ds_write_b128 v4, v[180:183] offset:24576
    ds_write_b128 v4, v[184:187] offset:25600
    ds_write_b128 v4, v[188:191] offset:26624
    ds_write_b128 v4, v[192:195] offset:36864
    ds_write_b128 v4, v[196:199] offset:37888
    ds_write_b128 v4, v[200:203] offset:38912
    s_barrier
    ds_write_b128 v5, v[204:207] offset:0
    ds_write_b128 v5, v[208:211] offset:1024
    ds_write_b128 v5, v[212:215] offset:2048
    ds_write_b128 v5, v[216:219] offset:12288
    ds_write_b128 v5, v[220:223] offset:13312
    ds_write_b128 v5, v[224:227] offset:14336
    ds_write_b128 v5, v[228:231] offset:24576
    ds_write_b128 v5, v[232:235] offset:25600
    ds_write_b128 v5, v[236:239] offset:26624
    ds_write_b128 v5, v[240:243] offset:36864
    ds_write_b128 v5, v[244:247] offset:37888
    ds_write_b128 v5, v[248:251] offset:38912
    s_barrier
    s_waitcnt lgkmcnt(0)
    s_barrier
    s_add_u32 m0, s98, 98304
    s_mov_b32 s99, 0
    buffer_load_dwordx4 v252, s[68:71], s99 offen offset:0 sc1 lds
    buffer_load_dwordx4 v252, s[68:71], s99 offen offset:1024 sc1 lds
    buffer_load_dwordx4 v252, s[68:71], s99 offen offset:2048 sc1 lds
    buffer_load_dwordx4 v252, s[68:71], s99 offen offset:3072 sc1 lds
    s_add_u32 m0, m0, 0x1000
    s_nop 0
    buffer_load_dwordx4 v253, s[68:71], s99 offen offset:0 sc1 lds
    s_mov_b32 s99, 163840
    buffer_load_dwordx4 v[72:75], v252, s[68:71], s99 offen offset:0 sc1
    buffer_load_dwordx4 v[76:79], v252, s[68:71], s99 offen offset:1024 sc1
    buffer_load_dwordx4 v[80:83], v252, s[68:71], s99 offen offset:2048 sc1
    buffer_load_dwordx4 v[84:87], v252, s[68:71], s99 offen offset:3072 sc1
    buffer_load_dwordx4 v[88:91], v253, s[68:71], s99 offen offset:0 sc1
    s_mov_b32 s99, 184320
    buffer_load_dwordx4 v[92:95], v252, s[68:71], s99 offen offset:0 sc1
    buffer_load_dwordx4 v[96:99], v252, s[68:71], s99 offen offset:1024 sc1
    buffer_load_dwordx4 v[100:103], v252, s[68:71], s99 offen offset:2048 sc1
    buffer_load_dwordx4 v[104:107], v252, s[68:71], s99 offen offset:3072 sc1
    buffer_load_dwordx4 v[108:111], v253, s[68:71], s99 offen offset:0 sc1
    s_mov_b32 s99, 204800
    buffer_load_dwordx4 v[112:115], v252, s[68:71], s99 offen offset:0 sc1
    buffer_load_dwordx4 v[116:119], v252, s[68:71], s99 offen offset:1024 sc1
    buffer_load_dwordx4 v[120:123], v252, s[68:71], s99 offen offset:2048 sc1
    buffer_load_dwordx4 v[124:127], v252, s[68:71], s99 offen offset:3072 sc1
    buffer_load_dwordx4 v[128:131], v253, s[68:71], s99 offen offset:0 sc1
    s_barrier
    s_add_u32 m0, s98, 122880
    s_mov_b32 s99, 20480
    buffer_load_dwordx4 v252, s[68:71], s99 offen offset:0 sc1 lds
    buffer_load_dwordx4 v252, s[68:71], s99 offen offset:1024 sc1 lds
    buffer_load_dwordx4 v252, s[68:71], s99 offen offset:2048 sc1 lds
    buffer_load_dwordx4 v252, s[68:71], s99 offen offset:3072 sc1 lds
    s_add_u32 m0, m0, 0x1000
    s_nop 0
    buffer_load_dwordx4 v253, s[68:71], s99 offen offset:0 sc1 lds
    s_add_u32 m0, s98, 0
    s_mov_b32 s99, 40960
    buffer_load_dwordx4 v252, s[68:71], s99 offen offset:0 sc1 lds
    buffer_load_dwordx4 v252, s[68:71], s99 offen offset:1024 sc1 lds
    buffer_load_dwordx4 v252, s[68:71], s99 offen offset:2048 sc1 lds
    buffer_load_dwordx4 v252, s[68:71], s99 offen offset:3072 sc1 lds
    s_add_u32 m0, m0, 0x1000
    s_nop 0
    buffer_load_dwordx4 v253, s[68:71], s99 offen offset:0 sc1 lds
    s_barrier
    s_add_u32 m0, s98, 24576
    s_mov_b32 s99, 61440
    buffer_load_dwordx4 v252, s[68:71], s99 offen offset:0 sc1 lds
    buffer_load_dwordx4 v252, s[68:71], s99 offen offset:1024 sc1 lds
    buffer_load_dwordx4 v252, s[68:71], s99 offen offset:2048 sc1 lds
    buffer_load_dwordx4 v252, s[68:71], s99 offen offset:3072 sc1 lds
    s_add_u32 m0, m0, 0x1000
    s_nop 0
    buffer_load_dwordx4 v253, s[68:71], s99 offen offset:0 sc1 lds
    s_add_u32 m0, s98, 49152
    s_mov_b32 s99, 81920
    buffer_load_dwordx4 v252, s[68:71], s99 offen offset:0 sc1 lds
    buffer_load_dwordx4 v252, s[68:71], s99 offen offset:1024 sc1 lds
    buffer_load_dwordx4 v252, s[68:71], s99 offen offset:2048 sc1 lds
    buffer_load_dwordx4 v252, s[68:71], s99 offen offset:3072 sc1 lds
    s_add_u32 m0, m0, 0x1000
    s_nop 0
    buffer_load_dwordx4 v253, s[68:71], s99 offen offset:0 sc1 lds
    s_waitcnt vmcnt(0)
    s_barrier
    ds_write_b128 v10, v[12:15] offset:24576
    ds_write_b128 v10, v[16:19] offset:25600
    ds_write_b128 v10, v[20:23] offset:26624
    ds_write_b128 v10, v[24:27] offset:27648
    ds_write_b128 v10, v[28:31] offset:28672
    s_barrier
    ds_write_b128 v11, v[32:35] offset:0
    ds_write_b128 v11, v[36:39] offset:1024
    ds_write_b128 v11, v[40:43] offset:2048
    ds_write_b128 v11, v[44:47] offset:3072
    ds_write_b128 v11, v[48:51] offset:4096
    ds_write_b128 v11, v[52:55] offset:24576
    ds_write_b128 v11, v[56:59] offset:25600
    ds_write_b128 v11, v[60:63] offset:26624
    ds_write_b128 v11, v[64:67] offset:27648
    ds_write_b128 v11, v[68:71] offset:28672
    s_waitcnt lgkmcnt(0)
    s_barrier
    ds_write_b128 v9, v[72:75] offset:0
    ds_write_b128 v9, v[76:79] offset:1024
    ds_write_b128 v9, v[80:83] offset:2048
    ds_write_b128 v9, v[84:87] offset:3072
    ds_write_b128 v9, v[88:91] offset:4096
    ds_write_b128 v9, v[92:95] offset:24576
    ds_write_b128 v9, v[96:99] offset:25600
    ds_write_b128 v9, v[100:103] offset:26624
    ds_write_b128 v9, v[104:107] offset:27648
    ds_write_b128 v9, v[108:111] offset:28672
    s_waitcnt lgkmcnt(0)
    s_barrier
    s_add_u32 m0, s98, 73728
    s_mov_b32 s99, 225280
    buffer_load_dwordx4 v252, s[68:71], s99 offen offset:0 sc1 lds
    buffer_load_dwordx4 v252, s[68:71], s99 offen offset:1024 sc1 lds
    buffer_load_dwordx4 v252, s[68:71], s99 offen offset:2048 sc1 lds
    buffer_load_dwordx4 v252, s[68:71], s99 offen offset:3072 sc1 lds
    s_add_u32 m0, m0, 0x1000
    s_nop 0
    buffer_load_dwordx4 v253, s[68:71], s99 offen offset:0 sc1 lds
    ds_write_b128 v10, v[112:115] offset:0
    ds_write_b128 v10, v[116:119] offset:1024
    ds_write_b128 v10, v[120:123] offset:2048
    ds_write_b128 v10, v[124:127] offset:3072
    ds_write_b128 v10, v[128:131] offset:4096
    s_waitcnt lgkmcnt(0)
    s_barrier
    s_waitcnt vmcnt(0)
    s_barrier
    s_endpgm
sequential_preLN__grouped_kv_mqa__dense_activation_squared_relu__prompt_kernel_pend:
    s_cmp_lt_u32 s54, 15
    s_cbranch_scc1 sequential_preLN__grouped_kv_mqa__dense_activation_squared_relu__prompt_kernel_pn_24
    s_waitcnt vmcnt(15)
    s_branch sequential_preLN__grouped_kv_mqa__dense_activation_squared_relu__prompt_kernel_pendx
sequential_preLN__grouped_kv_mqa__dense_activation_squared_relu__prompt_kernel_pn_24:
    s_cmp_lt_u32 s54, 12
    s_cbranch_scc1 sequential_preLN__grouped_kv_mqa__dense_activation_squared_relu__prompt_kernel_pn_25
    s_waitcnt vmcnt(12)
    s_branch sequential_preLN__grouped_kv_mqa__dense_activation_squared_relu__prompt_kernel_pendx
sequential_preLN__grouped_kv_mqa__dense_activation_squared_relu__prompt_kernel_pn_25:
    s_cmp_lt_u32 s54, 10
    s_cbranch_scc1 sequential_preLN__grouped_kv_mqa__dense_activation_squared_relu__prompt_kernel_pn_26
    s_waitcnt vmcnt(10)
    s_branch sequential_preLN__grouped_kv_mqa__dense_activation_squared_relu__prompt_kernel_pendx
sequential_preLN__grouped_kv_mqa__dense_activation_squared_relu__prompt_kernel_pn_26:
    s_cmp_lt_u32 s54, 8
    s_cbranch_scc1 sequential_preLN__grouped_kv_mqa__dense_activation_squared_relu__prompt_kernel_pn_27
    s_waitcnt vmcnt(8)
    s_branch sequential_preLN__grouped_kv_mqa__dense_activation_squared_relu__prompt_kernel_pendx
sequential_preLN__grouped_kv_mqa__dense_activation_squared_relu__prompt_kernel_pn_27:
    s_cmp_lt_u32 s54, 6
    s_cbranch_scc1 sequential_preLN__grouped_kv_mqa__dense_activation_squared_relu__prompt_kernel_pn_28
    s_waitcnt vmcnt(6)
    s_branch sequential_preLN__grouped_kv_mqa__dense_activation_squared_relu__prompt_kernel_pendx
sequential_preLN__grouped_kv_mqa__dense_activation_squared_relu__prompt_kernel_pn_28:
    s_cmp_lt_u32 s54, 5
    s_cbranch_scc1 sequential_preLN__grouped_kv_mqa__dense_activation_squared_relu__prompt_kernel_pn_29
    s_waitcnt vmcnt(5)
    s_branch sequential_preLN__grouped_kv_mqa__dense_activation_squared_relu__prompt_kernel_pendx
sequential_preLN__grouped_kv_mqa__dense_activation_squared_relu__prompt_kernel_pn_29:
    s_cmp_lt_u32 s54, 4
    s_cbranch_scc1 sequential_preLN__grouped_kv_mqa__dense_activation_squared_relu__prompt_kernel_pn_30
    s_waitcnt vmcnt(4)
    s_branch sequential_preLN__grouped_kv_mqa__dense_activation_squared_relu__prompt_kernel_pendx
sequential_preLN__grouped_kv_mqa__dense_activation_squared_relu__prompt_kernel_pn_30:
    s_cmp_lt_u32 s54, 2
    s_cbranch_scc1 sequential_preLN__grouped_kv_mqa__dense_activation_squared_relu__prompt_kernel_pn_31
    s_waitcnt vmcnt(2)
    s_branch sequential_preLN__grouped_kv_mqa__dense_activation_squared_relu__prompt_kernel_pendx
sequential_preLN__grouped_kv_mqa__dense_activation_squared_relu__prompt_kernel_pn_31:
    s_cmp_lt_u32 s54, 1
    s_cbranch_scc1 sequential_preLN__grouped_kv_mqa__dense_activation_squared_relu__prompt_kernel_pn_32
    s_waitcnt vmcnt(1)
    s_branch sequential_preLN__grouped_kv_mqa__dense_activation_squared_relu__prompt_kernel_pendx
sequential_preLN__grouped_kv_mqa__dense_activation_squared_relu__prompt_kernel_pn_32:
    s_waitcnt vmcnt(0)
    s_branch sequential_preLN__grouped_kv_mqa__dense_activation_squared_relu__prompt_kernel_pendx
sequential_preLN__grouped_kv_mqa__dense_activation_squared_relu__prompt_kernel_tree0:
    s_cmp_ge_u32 s3, 4
    s_cbranch_scc1 sequential_preLN__grouped_kv_mqa__dense_activation_squared_relu__prompt_kernel_tg_33
    s_cmp_ge_u32 s49, 4
    s_cbranch_scc1 sequential_preLN__grouped_kv_mqa__dense_activation_squared_relu__prompt_kernel_tr_34
    s_cmp_ge_u32 s49, 2
    s_cbranch_scc1 sequential_preLN__grouped_kv_mqa__dense_activation_squared_relu__prompt_kernel_tr_35
    s_cmp_ge_u32 s49, 1
    s_cbranch_scc1 sequential_preLN__grouped_kv_mqa__dense_activation_squared_relu__prompt_kernel_tr_36
    s_mov_b32 s62, s41
    v_writelane_b32 v2, s41, 0
    s_mov_b32 s6, s2
    s_cmp_ge_u32 s6, 136
    s_cbranch_scc1 sequential_preLN__grouped_kv_mqa__dense_activation_squared_relu__prompt_kernel_pk2
    s_cmp_ge_u32 s6, 96
    s_cbranch_scc1 sequential_preLN__grouped_kv_mqa__dense_activation_squared_relu__prompt_kernel_pk1
    s_mov_b32 s56, s20
    s_mov_b32 s57, s21
    s_mov_b32 s58, 0x1e0000
    s_mov_b32 s59, 0x00020000
    s_mov_b32 s96, 0
    s_mov_b32 s52, s6
    s_mov_b32 s62, s3
    s_and_b32 s53, s52, 3
    s_andn2_b32 s52, s52, 3
    s_or_b32 s52, s52, s62
    s_lshl_b32 s100, s53, 7
    s_lshl_b32 s6, s52, 9
    s_add_u32 s100, s100, s6
    s_add_u32 s100, s100, 4751360
    s_mov_b32 s40, s22
    s_mov_b32 s41, s23
    s_mov_b32 s42, 0xc00
    s_mov_b32 s43, 0x00020000
    s_lshl_b32 s6, s52, 5
    s_cmp_lg_u32 s53, 0
    s_cselect_b32 s6, 0x7ff00000, s6
    v_and_b32 v15, 15, v1
    v_lshlrev_b32 v15, 1, v15
    buffer_load_ushort v156, v15, s[40:43], s6 offen
    s_mul_i32 s101, s52, 171
    s_lshr_b32 s101, s101, 10
    s_mul_i32 s6, s101, 6
    s_sub_u32 s6, s52, s6
    s_mul_i32 s99, s6, 4
    s_add_u32 s99, s99, s53
    s_lshl_b32 s62, s99, 3
    s_mul_i32 s53, s53, 5
    s_mul_i32 s98, s101, 20
    s_add_u32 s98, s98, s53
    s_mul_i32 s98, s98, 6
    s_add_u32 s98, s98, s6
    s_lshl_b32 s98, s98, 10
    s_add_u32 s98, s98, 819200
    s_mov_b32 s99, 6144
    s_add_u32 s101, s101, 8
    s_lshl_b32 s101, s101, 9
    s_add_u32 s101, s101, s62
    s_add_u32 s101, s101, 790528
    s_mov_b32 s62, 98304
    s_branch sequential_preLN__grouped_kv_mqa__dense_activation_squared_relu__prompt_kernel_pkd
sequential_preLN__grouped_kv_mqa__dense_activation_squared_relu__prompt_kernel_pk1:
    s_mov_b32 s56, s16
    s_mov_b32 s57, s17
    s_mov_b32 s58, 0xc8000
    s_mov_b32 s59, 0x00020000
    s_mov_b32 s96, 1
    s_sub_u32 s6, s6, 96
    s_mov_b32 s52, s6
    s_mov_b32 s62, s3
    s_and_b32 s53, s52, 3
    s_andn2_b32 s52, s52, 3
    s_or_b32 s52, s52, s62
    s_mul_i32 s101, s52, 205
    s_lshr_b32 s101, s101, 10
    s_mul_i32 s6, s101, 5
    s_sub_u32 s6, s52, s6
    s_mul_i32 s99, s6, 4
    s_add_u32 s99, s99, s53
    s_lshl_b32 s62, s99, 3
    s_mul_i32 s53, s53, 5
    s_mul_i32 s98, s101, 20
    s_add_u32 s98, s98, s53
    s_mul_i32 s98, s98, 5
    s_add_u32 s98, s98, s6
    s_lshl_b32 s98, s98, 10
    s_mov_b32 s99, 5120
    s_add_u32 s101, s101, 0
    s_lshl_b32 s101, s101, 9
    s_add_u32 s101, s101, s62
    s_add_u32 s101, s101, 790528
    s_mov_b32 s62, 40960
    s_branch sequential_preLN__grouped_kv_mqa__dense_activation_squared_relu__prompt_kernel_pkd
sequential_preLN__grouped_kv_mqa__dense_activation_squared_relu__prompt_kernel_pk2:
    s_mov_b32 s56, s24
    s_mov_b32 s57, s25
    s_mov_b32 s58, 0x1e0000
    s_mov_b32 s59, 0x00020000
    s_mov_b32 s96, 2
    s_sub_u32 s6, s6, 136
    s_mov_b32 s52, s6
    s_mov_b32 s62, s3
    s_mov_b32 s6, s52
    s_mul_i32 s52, s6, 683
    s_lshr_b32 s52, s52, 13
    s_mul_i32 s53, s52, 12
    s_sub_u32 s53, s6, s53
    s_lshl_b32 s52, s52, 2
    s_or_b32 s52, s52, s62
    s_mul_i32 s101, s52, 205
    s_lshr_b32 s101, s101, 10
    s_mul_i32 s6, s101, 5
    s_sub_u32 s6, s52, s6
    s_mul_i32 s99, s6, 12
    s_add_u32 s99, s99, s53
    s_lshl_b32 s62, s99, 3
    s_mul_i32 s53, s53, 4
    s_mul_i32 s98, s101, 48
    s_add_u32 s98, s98, s53
    s_mul_i32 s98, s98, 5
    s_add_u32 s98, s98, s6
    s_lshl_b32 s98, s98, 10
    s_add_u32 s98, s98, 2785280
    s_mov_b32 s99, 5120
    s_add_u32 s101, s101, 24
    s_lshl_b32 s101, s101, 9
    s_add_u32 s101, s101, s62
    s_add_u32 s101, s101, 790528
    s_mov_b32 s62, 40960
sequential_preLN__grouped_kv_mqa__dense_activation_squared_relu__prompt_kernel_pkd:
    s_mul_i32 s53, s53, s62
    s_andn2_b32 s52, s52, 3
    s_lshl_b32 s52, s52, 5
    s_add_u32 s53, s53, s52
    s_lshr_b32 s6, s62, 5
    v_lshrrev_b32 v15, 3, v1
    s_mul_i32 s52, s3, 40
    v_add_u32 v15, s52, v15
    v_mul_lo_u32 v15, v15, s6
    v_and_b32 v16, 7, v1
    v_lshl_add_u32 v15, v16, 4, v15
    s_lshr_b32 s62, s62, 2
    s_mul_i32 s6, s3, 5120
    s_add_u32 m0, s6, 0
    s_nop 0
    buffer_load_dwordx4 v15, s[56:59], s53 offen lds
    s_add_u32 s53, s53, s62
    s_add_u32 m0, m0, 0x400
    s_nop 0
    buffer_load_dwordx4 v15, s[56:59], s53 offen lds
    s_add_u32 s53, s53, s62
    s_add_u32 m0, m0, 0x400
    s_nop 0
    buffer_load_dwordx4 v15, s[56:59], s53 offen lds
    s_add_u32 s53, s53, s62
    s_add_u32 m0, m0, 0x400
    s_nop 0
    buffer_load_dwordx4 v15, s[56:59], s53 offen lds
    s_add_u32 s53, s53, s62
    s_add_u32 m0, m0, 0x400
    s_nop 0
    buffer_load_dwordx4 v15, s[56:59], s53 offen lds
    v_readlane_b32 s41, v2, 0
    s_add_u32 s54, s54, 5
    s_branch sequential_preLN__grouped_kv_mqa__dense_activation_squared_relu__prompt_kernel_back0
sequential_preLN__grouped_kv_mqa__dense_activation_squared_relu__prompt_kernel_tr_36:
    s_getreg_b32 s52, hwreg(HW_REG_XCC_ID, 0, 4)
    s_lshl_b32 s52, s52, 28
    s_xor_b32 s52, s52, s94
    s_and_b32 s6, s2, 7
    s_lshl_b32 s53, s6, 8
    s_add_u32 s53, s53, 786432
    s_mov_b32 s53, s95
    v_cmp_ne_u64 vcc, s[52:53], v[18:19]
    s_cmp_eq_u64 vcc, 0
    s_cselect_b32 s55, 1, 0
    s_cmp_lg_u32 s55, 1
    s_cbranch_scc1 L_nt_37
    s_cmp_lg_u32 s3, 1
    s_cbranch_scc1 sequential_preLN__grouped_kv_mqa__dense_activation_squared_relu__prompt_kernel_ow_38
    s_and_b32 s53, s2, 7
    s_lshl_b32 s53, s53, 5
    s_lshr_b32 s6, s2, 3
    s_add_u32 s53, s53, s6
    s_add_u32 s56, s32, 0x300000
    s_addc_u32 s57, s33, 0
    s_mov_b32 s58, 0xd00000
    s_mov_b32 s59, 0x00020000
    v_lshlrev_b32 v15, 7, v1
    s_mul_i32 s6, s53, 10240
    s_add_u32 s6, s6, 3145728
    buffer_load_dword v255, v15, s[56:59], s6 offen sc1
    s_add_u32 s6, s6, 2048
    buffer_load_dword v255, v15, s[56:59], s6 offen sc1
    s_add_u32 s54, s54, 2
sequential_preLN__grouped_kv_mqa__dense_activation_squared_relu__prompt_kernel_ow_38:
L_nt_37:
    s_branch sequential_preLN__grouped_kv_mqa__dense_activation_squared_relu__prompt_kernel_back0
sequential_preLN__grouped_kv_mqa__dense_activation_squared_relu__prompt_kernel_tr_35:
    s_cmp_ge_u32 s49, 3
    s_cbranch_scc1 sequential_preLN__grouped_kv_mqa__dense_activation_squared_relu__prompt_kernel_tr_39
    v_lshrrev_b32 v152, 4, v1
    v_bfe_u32 v153, v1, 2, 2
    v_lshl_add_u32 v152, v152, 3, v153
    v_lshlrev_b32 v152, 7, v152
    v_and_b32 v153, 3, v1
    v_lshl_add_u32 v152, v153, 3, v152
    s_lshl_b32 s6, s3, 5
    s_add_u32 s6, s6, 0
    v_add_u32 v152, s6, v152
    s_waitcnt vmcnt(3)
    ds_read_b64_tr_b16 v[132:133], v152 offset:0
    ds_read_b64_tr_b16 v[134:135], v152 offset:512
    ds_read_b64_tr_b16 v[136:137], v152 offset:4096
    ds_read_b64_tr_b16 v[138:139], v152 offset:4608
    ds_read_b64_tr_b16 v[140:141], v152 offset:8192
    ds_read_b64_tr_b16 v[142:143], v152 offset:8704
    ds_read_b64_tr_b16 v[144:145], v152 offset:12288
    ds_read_b64_tr_b16 v[146:147], v152 offset:12800
    ds_read_b64_tr_b16 v[148:149], v152 offset:16384
    ds_read_b64_tr_b16 v[150:151], v152 offset:16896
    v_mov_b32 v153, 0
    v_mov_b32 v154, 0x3f803f80
    s_add_u32 s54, s54, 4
    s_waitcnt lgkmcnt(0)
    buffer_store_dwordx4 v[132:135], v8, s[68:71], s98 offen sc1
    s_add_u32 s98, s98, s99
    buffer_store_dwordx4 v[136:139], v8, s[68:71], s98 offen sc1
    s_add_u32 s98, s98, s99
    buffer_store_dwordx4 v[140:143], v8, s[68:71], s98 offen sc1
    s_add_u32 s98, s98, s99
    buffer_store_dwordx4 v[144:147], v8, s[68:71], s98 offen sc1
    s_add_u32 s98, s98, s99
    s_cmp_eq_u32 s96, 2
    s_cbranch_scc1 sequential_preLN__grouped_kv_mqa__dense_activation_squared_relu__prompt_kernel_pkx_40
    buffer_store_dwordx4 v[148:151], v8, s[68:71], s98 offen sc1
    s_add_u32 s98, s98, s99
    s_add_u32 s54, s54, 1
    s_cmp_lg_u32 s96, 0
    s_cbranch_scc1 sequential_preLN__grouped_kv_mqa__dense_activation_squared_relu__prompt_kernel_pkx_40
    v_dot2_f32_bf16 v153, v132, v154, v153
    v_dot2_f32_bf16 v153, v133, v154, v153
    v_dot2_f32_bf16 v153, v134, v154, v153
    v_dot2_f32_bf16 v153, v135, v154, v153
    v_dot2_f32_bf16 v153, v136, v154, v153
    v_dot2_f32_bf16 v153, v137, v154, v153
    v_dot2_f32_bf16 v153, v138, v154, v153
    v_dot2_f32_bf16 v153, v139, v154, v153
    v_dot2_f32_bf16 v153, v140, v154, v153
    v_dot2_f32_bf16 v153, v141, v154, v153
    v_dot2_f32_bf16 v153, v142, v154, v153
    v_dot2_f32_bf16 v153, v143, v154, v153
    v_dot2_f32_bf16 v153, v144, v154, v153
    v_dot2_f32_bf16 v153, v145, v154, v153
    v_dot2_f32_bf16 v153, v146, v154, v153
    v_dot2_f32_bf16 v153, v147, v154, v153
    v_dot2_f32_bf16 v153, v148, v154, v153
    v_dot2_f32_bf16 v153, v149, v154, v153
    v_dot2_f32_bf16 v153, v150, v154, v153
    v_dot2_f32_bf16 v153, v151, v154, v153
    s_nop 3
    v_mov_b32 v155, v153
    s_nop 1
    v_permlane16_swap_b32 v153, v155
    s_nop 1
    v_add_f32 v153, v153, v155
    v_mov_b32 v155, v153
    s_nop 1
    v_permlane32_swap_b32 v153, v155
    s_nop 1
    v_add_f32 v153, v153, v155
    v_cvt_pk_bf16_f32 v154, v153, v153
    v_lshlrev_b32 v154, 16, v154
    v_sub_f32 v153, v153, v154
    v_cvt_pk_bf16_f32 v155, v153, v153
    v_lshlrev_b32 v155, 16, v155
    v_sub_f32 v153, v153, v155
    v_cvt_pk_bf16_f32 v154, v154, v155
    v_cvt_pk_bf16_f32 v155, v153, 0
    v_lshl_or_b32 v155, v156, 16, v155
    v_lshlrev_b32 v152, 3, v1
    s_mov_b32 exec_lo, 0xffff
    s_mov_b32 exec_hi, 0x0
    buffer_store_dwordx2 v[154:155], v152, s[68:71], s100 offen sc1
    s_mov_b64 exec, -1
    s_add_u32 s54, s54, 1
sequential_preLN__grouped_kv_mqa__dense_activation_squared_relu__prompt_kernel_pkx_40:
    s_branch sequential_preLN__grouped_kv_mqa__dense_activation_squared_relu__prompt_kernel_back0
sequential_preLN__grouped_kv_mqa__dense_activation_squared_relu__prompt_kernel_tr_39:
    v_mov_b32 v15, 0
    v_mov_b32 v16, s94
    v_mov_b32 v17, s95
    s_waitcnt vmcnt(3)
    s_mov_b64 exec, 1
    buffer_store_dwordx2 v[16:17], v15, s[64:67], s101 offen sc1
    s_mov_b64 exec, -1
    s_add_u32 s54, s54, 1
    s_branch sequential_preLN__grouped_kv_mqa__dense_activation_squared_relu__prompt_kernel_back0
sequential_preLN__grouped_kv_mqa__dense_activation_squared_relu__prompt_kernel_tr_34:
    s_cmp_ge_u32 s49, 6
    s_cbranch_scc1 sequential_preLN__grouped_kv_mqa__dense_activation_squared_relu__prompt_kernel_tr_41
    s_cmp_ge_u32 s49, 5
    s_cbranch_scc1 sequential_preLN__grouped_kv_mqa__dense_activation_squared_relu__prompt_kernel_tr_42
    s_cmp_lg_u32 s3, 1
    s_cbranch_scc1 sequential_preLN__grouped_kv_mqa__dense_activation_squared_relu__prompt_kernel_ow_43
    s_add_u32 s52, s5, 0
    s_lshl_b32 s52, s52, 9
    s_add_u32 s52, s52, 790528
    v_min_u32 v15, 19, v1
    v_lshlrev_b32 v15, 3, v15
    s_mov_b32 s53, 262144
L_pc_44:
    buffer_load_dwordx2 v[16:17], v15, s[64:67], s52 offen sc1
    s_sub_u32 s53, s53, 1
    s_cmp_eq_u32 s53, 0
    s_cbranch_scc1 L_pc_44_x
    s_waitcnt vmcnt(0)
    v_cmp_ne_u64 vcc, s[94:95], v[16:17]
    s_cbranch_vccnz L_pc_44
L_pc_44_x:
sequential_preLN__grouped_kv_mqa__dense_activation_squared_relu__prompt_kernel_ow_43:
    s_branch sequential_preLN__grouped_kv_mqa__dense_activation_squared_relu__prompt_kernel_back0
sequential_preLN__grouped_kv_mqa__dense_activation_squared_relu__prompt_kernel_tr_42:
    s_cmp_lg_u32 s3, 2
    s_cbranch_scc1 sequential_preLN__grouped_kv_mqa__dense_activation_squared_relu__prompt_kernel_ow_45
    s_add_u32 s52, s61, 8
    s_lshl_b32 s52, s52, 9
    s_add_u32 s52, s52, 790528
    v_min_u32 v15, 23, v1
    v_lshlrev_b32 v15, 3, v15
    s_mov_b32 s53, 262144
L_pc_46:
    buffer_load_dwordx2 v[16:17], v15, s[64:67], s52 offen sc1
    s_sub_u32 s53, s53, 1
    s_cmp_eq_u32 s53, 0
    s_cbranch_scc1 L_pc_46_x
    s_waitcnt vmcnt(0)
    v_cmp_ne_u64 vcc, s[94:95], v[16:17]
    s_cbranch_vccnz L_pc_46
L_pc_46_x:
sequential_preLN__grouped_kv_mqa__dense_activation_squared_relu__prompt_kernel_ow_45:
    s_cmp_lg_u32 s3, 3
    s_cbranch_scc1 sequential_preLN__grouped_kv_mqa__dense_activation_squared_relu__prompt_kernel_ow_47
    s_add_u32 s52, s5, 24
    s_lshl_b32 s52, s52, 9
    s_add_u32 s52, s52, 790528
    v_min_u32 v15, 59, v1
    v_lshlrev_b32 v15, 3, v15
    s_mov_b32 s53, 262144
L_pc_48:
    buffer_load_dwordx2 v[16:17], v15, s[64:67], s52 offen sc1
    s_sub_u32 s53, s53, 1
    s_cmp_eq_u32 s53, 0
    s_cbranch_scc1 L_pc_48_x
    s_waitcnt vmcnt(0)
    v_cmp_ne_u64 vcc, s[94:95], v[16:17]
    s_cbranch_vccnz L_pc_48
L_pc_48_x:
sequential_preLN__grouped_kv_mqa__dense_activation_squared_relu__prompt_kernel_ow_47:
    s_branch sequential_preLN__grouped_kv_mqa__dense_activation_squared_relu__prompt_kernel_back0
sequential_preLN__grouped_kv_mqa__dense_activation_squared_relu__prompt_kernel_tr_41:
    s_cmp_ge_u32 s49, 7
    s_cbranch_scc1 sequential_preLN__grouped_kv_mqa__dense_activation_squared_relu__prompt_kernel_tr_49
    v_lshrrev_b32 v15, 4, v1
    s_mov_b32 s56, s8
    s_mov_b32 s57, s9
    s_mov_b32 s58, 0x280000
    s_mov_b32 s59, 0x00020000
    s_and_b32 s52, s3, 1
    s_lshl_b32 s52, s52, 1
    s_lshr_b32 s53, s3, 1
    s_add_u32 s52, s52, s53
    s_lshl_b32 s6, s4, 2
    s_add_u32 s6, s6, s52
    s_lshl_b32 s6, s6, 4
    v_and_b32 v16, 15, v1
    v_add_u32 v16, s6, v16
    v_mul_u32_u24 v16, 1280, v16
    v_lshl_add_u32 v16, v15, 3, v16
    s_mul_i32 s6, s5, 160
    buffer_load_dwordx2 v[210:211], v16, s[56:59], s6 offen offset:0
    buffer_load_dwordx2 v[212:213], v16, s[56:59], s6 offen offset:32
    buffer_load_dwordx2 v[214:215], v16, s[56:59], s6 offen offset:64
    buffer_load_dwordx2 v[216:217], v16, s[56:59], s6 offen offset:96
    buffer_load_dwordx2 v[218:219], v16, s[56:59], s6 offen offset:128
    s_mov_b32 s56, s26
    s_mov_b32 s57, s27
    s_mov_b32 s58, 0x500
    s_mov_b32 s59, 0x00020000
    v_lshlrev_b32 v16, 5, v1
    buffer_load_dword v255, v16, s[56:59], 0 offen
    s_add_u32 s54, s54, 6
    s_branch sequential_preLN__grouped_kv_mqa__dense_activation_squared_relu__prompt_kernel_back0
sequential_preLN__grouped_kv_mqa__dense_activation_squared_relu__prompt_kernel_tr_49:
    s_branch sequential_preLN__grouped_kv_mqa__dense_activation_squared_relu__prompt_kernel_back0
sequential_preLN__grouped_kv_mqa__dense_activation_squared_relu__prompt_kernel_tg_33:
    s_branch sequential_preLN__grouped_kv_mqa__dense_activation_squared_relu__prompt_kernel_back0
sequential_preLN__grouped_kv_mqa__dense_activation_squared_relu__prompt_kernel_tree1:
    s_cmp_ge_u32 s3, 4
    s_cbranch_scc1 sequential_preLN__grouped_kv_mqa__dense_activation_squared_relu__prompt_kernel_tg_50
    s_cmp_ge_u32 s49, 4
    s_cbranch_scc1 sequential_preLN__grouped_kv_mqa__dense_activation_squared_relu__prompt_kernel_tr_51
    s_branch sequential_preLN__grouped_kv_mqa__dense_activation_squared_relu__prompt_kernel_back1
sequential_preLN__grouped_kv_mqa__dense_activation_squared_relu__prompt_kernel_tr_51:
    s_cmp_ge_u32 s49, 6
    s_cbranch_scc1 sequential_preLN__grouped_kv_mqa__dense_activation_squared_relu__prompt_kernel_tr_52
    s_branch sequential_preLN__grouped_kv_mqa__dense_activation_squared_relu__prompt_kernel_back1
sequential_preLN__grouped_kv_mqa__dense_activation_squared_relu__prompt_kernel_tr_52:
    s_cmp_ge_u32 s49, 7
    s_cbranch_scc1 sequential_preLN__grouped_kv_mqa__dense_activation_squared_relu__prompt_kernel_tr_53
    s_branch sequential_preLN__grouped_kv_mqa__dense_activation_squared_relu__prompt_kernel_back1
sequential_preLN__grouped_kv_mqa__dense_activation_squared_relu__prompt_kernel_tr_53:
    v_lshlrev_b32 v200, 16, v210
    v_and_b32 v201, 0xffff0000, v210
    v_lshlrev_b32 v202, 16, v211
    v_and_b32 v203, 0xffff0000, v211
    v_lshlrev_b32 v204, 16, v212
    v_and_b32 v205, 0xffff0000, v212
    v_lshlrev_b32 v206, 16, v213
    v_and_b32 v207, 0xffff0000, v213
    v_lshlrev_b32 v208, 16, v214
    v_and_b32 v209, 0xffff0000, v214
    v_lshlrev_b32 v210, 16, v215
    v_and_b32 v211, 0xffff0000, v215
    v_lshlrev_b32 v212, 16, v216
    v_and_b32 v213, 0xffff0000, v216
    v_lshlrev_b32 v214, 16, v217
    v_and_b32 v215, 0xffff0000, v217
    v_lshlrev_b32 v216, 16, v218
    v_and_b32 v217, 0xffff0000, v218
    v_lshlrev_b32 v218, 16, v219
    v_and_b32 v219, 0xffff0000, v219
    s_branch sequential_preLN__grouped_kv_mqa__dense_activation_squared_relu__prompt_kernel_back1
sequential_preLN__grouped_kv_mqa__dense_activation_squared_relu__prompt_kernel_tg_50:
    s_cmp_ge_u32 s49, 4
    s_cbranch_scc1 sequential_preLN__grouped_kv_mqa__dense_activation_squared_relu__prompt_kernel_tr_54
    s_cmp_ge_u32 s49, 2
    s_cbranch_scc1 sequential_preLN__grouped_kv_mqa__dense_activation_squared_relu__prompt_kernel_tr_55
    s_cmp_ge_u32 s49, 1
    s_cbranch_scc1 sequential_preLN__grouped_kv_mqa__dense_activation_squared_relu__prompt_kernel_tr_56
    s_getreg_b32 s52, hwreg(HW_REG_XCC_ID, 0, 4)
    s_lshl_b32 s52, s52, 28
    s_xor_b32 s52, s52, s94
    s_and_b32 s6, s2, 7
    s_lshl_b32 s53, s6, 8
    s_add_u32 s53, s53, 786432
    s_mov_b32 s53, s95
    v_cmp_ne_u64 vcc, s[52:53], v[18:19]
    s_cmp_eq_u64 vcc, 0
    s_cselect_b32 s55, 1, 0
    s_cmp_lg_u32 s55, 1
    s_cbranch_scc1 L_nt_57
    s_cmp_lg_u32 s3, 4
    s_cbranch_scc1 sequential_preLN__grouped_kv_mqa__dense_activation_squared_relu__prompt_kernel_ow_58
    s_and_b32 s53, s2, 7
    s_lshl_b32 s53, s53, 5
    s_lshr_b32 s6, s2, 3
    s_add_u32 s53, s53, s6
    s_add_u32 s56, s32, 0x300000
    s_addc_u32 s57, s33, 0
    s_mov_b32 s58, 0xd00000
    s_mov_b32 s59, 0x00020000
    v_lshlrev_b32 v15, 7, v1
    v_lshrrev_b32 v16, 3, v1
    v_min_u32 v16, 2, v16
    v_lshlrev_b32 v16, 18, v16
    v_and_b32 v17, 0x3ff, v15
    v_add_u32 v16, v16, v17
    s_lshl_b32 s6, s53, 10
    buffer_load_dword v255, v16, s[64:67], s6 offen sc1
    s_mul_i32 s6, s53, 10240
    buffer_load_dword v255, v15, s[56:59], s6 offen sc1
    s_add_u32 s6, s6, 2048
    buffer_load_dword v255, v15, s[56:59], s6 offen sc1
    s_add_u32 s54, s54, 2
sequential_preLN__grouped_kv_mqa__dense_activation_squared_relu__prompt_kernel_ow_58:
L_nt_57:
    s_branch sequential_preLN__grouped_kv_mqa__dense_activation_squared_relu__prompt_kernel_back1
sequential_preLN__grouped_kv_mqa__dense_activation_squared_relu__prompt_kernel_tr_56:
    s_cmp_lg_u32 s55, 1
    s_cbranch_scc1 L_nt_59
    s_cmp_lg_u32 s3, 6
    s_cbranch_scc1 sequential_preLN__grouped_kv_mqa__dense_activation_squared_relu__prompt_kernel_ow_60
    s_and_b32 s53, s2, 7
    s_lshl_b32 s53, s53, 5
    s_lshr_b32 s6, s2, 3
    s_add_u32 s53, s53, s6
    s_add_u32 s56, s32, 0x300000
    s_addc_u32 s57, s33, 0
    s_mov_b32 s58, 0xd00000
    s_mov_b32 s59, 0x00020000
    v_lshlrev_b32 v15, 7, v1
    s_mul_i32 s6, s53, 24576
    s_add_u32 s6, s6, 7340032
    buffer_load_dword v255, v15, s[56:59], s6 offen sc1
    s_add_u32 s6, s6, 8192
    buffer_load_dword v255, v15, s[56:59], s6 offen sc1
    s_add_u32 s54, s54, 2
sequential_preLN__grouped_kv_mqa__dense_activation_squared_relu__prompt_kernel_ow_60:
L_nt_59:
    s_branch sequential_preLN__grouped_kv_mqa__dense_activation_squared_relu__prompt_kernel_back1
sequential_preLN__grouped_kv_mqa__dense_activation_squared_relu__prompt_kernel_tr_55:
    s_cmp_ge_u32 s49, 3
    s_cbranch_scc1 sequential_preLN__grouped_kv_mqa__dense_activation_squared_relu__prompt_kernel_tr_61
    s_cmp_lg_u32 s55, 1
    s_cbranch_scc1 L_nt_62
    s_cmp_lg_u32 s3, 4
    s_cbranch_scc1 sequential_preLN__grouped_kv_mqa__dense_activation_squared_relu__prompt_kernel_ow_63
    s_and_b32 s53, s2, 7
    s_lshl_b32 s53, s53, 5
    s_lshr_b32 s6, s2, 3
    s_add_u32 s53, s53, s6
    s_add_u32 s56, s32, 0x300000
    s_addc_u32 s57, s33, 0
    s_mov_b32 s58, 0xd00000
    s_mov_b32 s59, 0x00020000
    v_lshlrev_b32 v15, 7, v1
    s_mul_i32 s6, s53, 24576
    s_add_u32 s6, s6, 7356416
    buffer_load_dword v255, v15, s[56:59], s6 offen sc1
    s_lshl_b32 s6, s53, 9
    s_add_u32 s6, s6, 6291456
    v_and_b32 v15, 0x1ff, v15
    buffer_load_dword v255, v15, s[56:59], s6 offen sc1
    s_add_u32 s54, s54, 2
sequential_preLN__grouped_kv_mqa__dense_activation_squared_relu__prompt_kernel_ow_63:
L_nt_62:
    s_branch sequential_preLN__grouped_kv_mqa__dense_activation_squared_relu__prompt_kernel_back1
sequential_preLN__grouped_kv_mqa__dense_activation_squared_relu__prompt_kernel_tr_61:
    s_branch sequential_preLN__grouped_kv_mqa__dense_activation_squared_relu__prompt_kernel_back1
sequential_preLN__grouped_kv_mqa__dense_activation_squared_relu__prompt_kernel_tr_54:
    s_cmp_ge_u32 s49, 6
    s_cbranch_scc1 sequential_preLN__grouped_kv_mqa__dense_activation_squared_relu__prompt_kernel_tr_64
    s_cmp_ge_u32 s49, 5
    s_cbranch_scc1 sequential_preLN__grouped_kv_mqa__dense_activation_squared_relu__prompt_kernel_tr_65
    s_sub_u32 s99, s3, 4
    s_mul_i32 s6, s5, 102400
    s_mul_i32 s98, s99, 5120
    s_add_u32 s6, s6, s98
    s_add_u32 s6, s6, 0
    v_add_u32 v252, s6, v8
    v_add_u32 v253, 0x1000, v252
    s_lshr_b32 s98, s99, 1
    s_mul_i32 s98, s98, 12288
    s_and_b32 s99, s99, 1
    s_mul_i32 s99, s99, 5120
    s_add_u32 s98, s98, s99
    s_sub_u32 s52, s3, 4
    s_mul_i32 s52, s52, 3072
    s_mul_i32 s6, s61, 122880
    s_add_u32 s6, s6, s52
    s_add_u32 s6, s6, 819200
    v_add_u32 v254, s6, v8
    s_add_u32 m0, s98, 0
    s_mov_b32 s99, 0
    buffer_load_dwordx4 v252, s[68:71], s99 offen offset:0 sc1 lds
    buffer_load_dwordx4 v252, s[68:71], s99 offen offset:1024 sc1 lds
    buffer_load_dwordx4 v252, s[68:71], s99 offen offset:2048 sc1 lds
    buffer_load_dwordx4 v252, s[68:71], s99 offen offset:3072 sc1 lds
    s_add_u32 m0, m0, 0x1000
    s_nop 0
    buffer_load_dwordx4 v253, s[68:71], s99 offen offset:0 sc1 lds
    s_add_u32 s54, s54, 5
    s_add_u32 m0, s98, 24576
    s_mov_b32 s99, 20480
    buffer_load_dwordx4 v252, s[68:71], s99 offen offset:0 sc1 lds
    buffer_load_dwordx4 v252, s[68:71], s99 offen offset:1024 sc1 lds
    buffer_load_dwordx4 v252, s[68:71], s99 offen offset:2048 sc1 lds
    buffer_load_dwordx4 v252, s[68:71], s99 offen offset:3072 sc1 lds
    s_add_u32 m0, m0, 0x1000
    s_nop 0
    buffer_load_dwordx4 v253, s[68:71], s99 offen offset:0 sc1 lds
    s_add_u32 s54, s54, 5
    s_add_u32 m0, s98, 49152
    s_mov_b32 s99, 40960
    buffer_load_dwordx4 v252, s[68:71], s99 offen offset:0 sc1 lds
    buffer_load_dwordx4 v252, s[68:71], s99 offen offset:1024 sc1 lds
    buffer_load_dwordx4 v252, s[68:71], s99 offen offset:2048 sc1 lds
    buffer_load_dwordx4 v252, s[68:71], s99 offen offset:3072 sc1 lds
    s_add_u32 m0, m0, 0x1000
    s_nop 0
    buffer_load_dwordx4 v253, s[68:71], s99 offen offset:0 sc1 lds
    s_add_u32 s54, s54, 5
    s_branch sequential_preLN__grouped_kv_mqa__dense_activation_squared_relu__prompt_kernel_back1
sequential_preLN__grouped_kv_mqa__dense_activation_squared_relu__prompt_kernel_tr_65:
    s_mov_b32 s6, 0
    buffer_load_dwordx4 v[132:135], v254, s[68:71], s6 offen offset:0 sc1
    s_mov_b32 s6, 0
    buffer_load_dwordx4 v[136:139], v254, s[68:71], s6 offen offset:1024 sc1
    s_mov_b32 s6, 0
    buffer_load_dwordx4 v[140:143], v254, s[68:71], s6 offen offset:2048 sc1
    s_mov_b32 s6, 12288
    buffer_load_dwordx4 v[144:147], v254, s[68:71], s6 offen offset:0 sc1
    s_mov_b32 s6, 12288
    buffer_load_dwordx4 v[148:151], v254, s[68:71], s6 offen offset:1024 sc1
    s_add_u32 s54, s54, 5
    s_mov_b32 s6, 12288
    buffer_load_dwordx4 v[152:155], v254, s[68:71], s6 offen offset:2048 sc1
    s_mov_b32 s6, 24576
    buffer_load_dwordx4 v[156:159], v254, s[68:71], s6 offen offset:0 sc1
    s_mov_b32 s6, 24576
    buffer_load_dwordx4 v[160:163], v254, s[68:71], s6 offen offset:1024 sc1
    s_mov_b32 s6, 24576
    buffer_load_dwordx4 v[164:167], v254, s[68:71], s6 offen offset:2048 sc1
    s_mov_b32 s6, 36864
    buffer_load_dwordx4 v[168:171], v254, s[68:71], s6 offen offset:0 sc1
    s_add_u32 s54, s54, 5
    s_mov_b32 s6, 36864
    buffer_load_dwordx4 v[172:175], v254, s[68:71], s6 offen offset:1024 sc1
    s_mov_b32 s6, 36864
    buffer_load_dwordx4 v[176:179], v254, s[68:71], s6 offen offset:2048 sc1
    s_mov_b32 s6, 49152
    buffer_load_dwordx4 v[180:183], v254, s[68:71], s6 offen offset:0 sc1
    s_mov_b32 s6, 49152
    buffer_load_dwordx4 v[184:187], v254, s[68:71], s6 offen offset:1024 sc1
    s_mov_b32 s6, 49152
    buffer_load_dwordx4 v[188:191], v254, s[68:71], s6 offen offset:2048 sc1
    s_add_u32 s54, s54, 5
    s_branch sequential_preLN__grouped_kv_mqa__dense_activation_squared_relu__prompt_kernel_back1
sequential_preLN__grouped_kv_mqa__dense_activation_squared_relu__prompt_kernel_tr_64:
    s_cmp_ge_u32 s49, 7
    s_cbranch_scc1 sequential_preLN__grouped_kv_mqa__dense_activation_squared_relu__prompt_kernel_tr_66
    s_mov_b32 s6, 61440
    buffer_load_dwordx4 v[192:195], v254, s[68:71], s6 offen offset:0 sc1
    s_mov_b32 s6, 61440
    buffer_load_dwordx4 v[196:199], v254, s[68:71], s6 offen offset:1024 sc1
    s_mov_b32 s6, 61440
    buffer_load_dwordx4 v[200:203], v254, s[68:71], s6 offen offset:2048 sc1
    s_mov_b32 s6, 73728
    buffer_load_dwordx4 v[204:207], v254, s[68:71], s6 offen offset:0 sc1
    s_mov_b32 s6, 73728
    buffer_load_dwordx4 v[208:211], v254, s[68:71], s6 offen offset:1024 sc1
    s_add_u32 s54, s54, 5
    s_mov_b32 s6, 73728
    buffer_load_dwordx4 v[212:215], v254, s[68:71], s6 offen offset:2048 sc1
    s_mov_b32 s6, 86016
    buffer_load_dwordx4 v[216:219], v254, s[68:71], s6 offen offset:0 sc1
    s_mov_b32 s6, 86016
    buffer_load_dwordx4 v[220:223], v254, s[68:71], s6 offen offset:1024 sc1
    s_mov_b32 s6, 86016
    buffer_load_dwordx4 v[224:227], v254, s[68:71], s6 offen offset:2048 sc1
    s_mov_b32 s6, 98304
    buffer_load_dwordx4 v[228:231], v254, s[68:71], s6 offen offset:0 sc1
    s_add_u32 s54, s54, 5
    s_mov_b32 s6, 98304
    buffer_load_dwordx4 v[232:235], v254, s[68:71], s6 offen offset:1024 sc1
    s_mov_b32 s6, 98304
    buffer_load_dwordx4 v[236:239], v254, s[68:71], s6 offen offset:2048 sc1
    s_mov_b32 s6, 110592
    buffer_load_dwordx4 v[240:243], v254, s[68:71], s6 offen offset:0 sc1
    s_mov_b32 s6, 110592
    buffer_load_dwordx4 v[244:247], v254, s[68:71], s6 offen offset:1024 sc1
    s_mov_b32 s6, 110592
    buffer_load_dwordx4 v[248:251], v254, s[68:71], s6 offen offset:2048 sc1
    s_add_u32 s54, s54, 5
    s_branch sequential_preLN__grouped_kv_mqa__dense_activation_squared_relu__prompt_kernel_back1
sequential_preLN__grouped_kv_mqa__dense_activation_squared_relu__prompt_kernel_tr_66:
    s_branch sequential_preLN__grouped_kv_mqa__dense_activation_squared_relu__prompt_kernel_back1
sequential_preLN__grouped_kv_mqa__dense_activation_squared_relu__prompt_kernel_slow:
    s_mov_b32 exec_lo, 0x0
    s_mov_b32 exec_hi, 0xffffffff
    v_mov_b32 v24, 0
    v_mov_b32 v25, 0
    s_mov_b64 exec, -1
    v_mov_b32 v13, 0xff800000
    s_mov_b32 s48, 0
sequential_preLN__grouped_kv_mqa__dense_activation_squared_relu__prompt_kernel_slow1:
    buffer_load_dwordx4 v[32:35], v8, s[36:39], s48 offen sc1
    buffer_load_dwordx2 v[36:37], v9, s[36:39], s48 offen sc1
    s_waitcnt vmcnt(0)
    v_mfma_f32_32x32x16_bf16 v[68:83], v[32:35], v[20:23], 0
    v_mfma_f32_32x32x8_bf16 v[68:83], v[36:37], v[24:25], v[68:83]
    s_nop 7
    s_nop 7
    v_max3_f32 v13, v13, v68, v69
    v_max3_f32 v13, v13, v70, v71
    v_max3_f32 v13, v13, v72, v73
    v_max3_f32 v13, v13, v74, v75
    v_max3_f32 v13, v13, v76, v77
    v_max3_f32 v13, v13, v78, v79
    v_max3_f32 v13, v13, v80, v81
    v_max3_f32 v13, v13, v82, v83
    s_add_u32 s48, s48, 2816
    s_cmp_lt_u32 s48, 180224
    s_cbranch_scc1 sequential_preLN__grouped_kv_mqa__dense_activation_squared_relu__prompt_kernel_slow1
    v_mov_b32 v14, v13
    s_nop 1
    v_permlane32_swap_b32 v13, v14
    s_nop 1
    v_max_f32 v13, v13, v14
    v_sub_f32 v13, 0, v13
    v_cvt_pk_bf16_f32 v14, v13, v13
    v_lshlrev_b32 v14, 16, v14
    v_sub_f32 v15, v13, v14
    v_cvt_pk_bf16_f32 v16, v15, v15
    v_lshlrev_b32 v16, 16, v16
    v_sub_f32 v15, v15, v16
    s_mov_b32 exec_lo, 0x0
    s_mov_b32 exec_hi, 0xffffffff
    v_cvt_pk_bf16_f32 v24, v14, v16
    v_cvt_pk_bf16_f32 v25, v15, 0
    s_mov_b64 exec, -1
    v_mov_b32 v100, 0
    v_mov_b32 v101, 0
    v_mov_b32 v102, 0
    v_mov_b32 v103, 0
    v_mov_b32 v104, 0
    v_mov_b32 v105, 0
    v_mov_b32 v106, 0
    v_mov_b32 v107, 0
    v_mov_b32 v108, 0
    v_mov_b32 v109, 0
    v_mov_b32 v110, 0
    v_mov_b32 v111, 0
    v_mov_b32 v112, 0
    v_mov_b32 v113, 0
    v_mov_b32 v114, 0
    v_mov_b32 v115, 0
    s_mov_b32 s48, 0
sequential_preLN__grouped_kv_mqa__dense_activation_squared_relu__prompt_kernel_slow2:
    buffer_load_dwordx4 v[32:35], v8, s[36:39], s48 offen sc1
    buffer_load_dwordx2 v[36:37], v9, s[36:39], s48 offen sc1
    buffer_load_dwordx4 v[44:47], v10, s[36:39], s48 offen sc1
    buffer_load_dwordx4 v[48:51], v10, s[36:39], s48 offen offset:768 sc1
    s_waitcnt vmcnt(0)
    v_mfma_f32_32x32x16_bf16 v[68:83], v[32:35], v[20:23], 0
    v_mfma_f32_32x32x8_bf16 v[68:83], v[36:37], v[24:25], v[68:83]
    s_nop 7
    s_nop 7
    v_exp_f32 v68, v68
    v_exp_f32 v69, v69
    v_exp_f32 v70, v70
    v_exp_f32 v71, v71
    v_exp_f32 v72, v72
    v_exp_f32 v73, v73
    v_exp_f32 v74, v74
    v_exp_f32 v75, v75
    v_exp_f32 v76, v76
    v_exp_f32 v77, v77
    v_exp_f32 v78, v78
    v_exp_f32 v79, v79
    v_exp_f32 v80, v80
    v_exp_f32 v81, v81
    v_exp_f32 v82, v82
    v_exp_f32 v83, v83
    s_nop 0
    v_cvt_pk_bf16_f32 v60, v68, v69
    v_cvt_pk_bf16_f32 v61, v70, v71
    v_cvt_pk_bf16_f32 v62, v72, v73
    v_cvt_pk_bf16_f32 v63, v74, v75
    v_cvt_pk_bf16_f32 v64, v76, v77
    v_cvt_pk_bf16_f32 v65, v78, v79
    v_cvt_pk_bf16_f32 v66, v80, v81
    v_cvt_pk_bf16_f32 v67, v82, v83
    s_nop 1
    v_mfma_f32_32x32x16_bf16 v[100:115], v[44:47], v[60:63], v[100:115]
    v_mfma_f32_32x32x16_bf16 v[100:115], v[48:51], v[64:67], v[100:115]
    s_add_u32 s48, s48, 2816
    s_cmp_lt_u32 s48, 180224
    s_cbranch_scc1 sequential_preLN__grouped_kv_mqa__dense_activation_squared_relu__prompt_kernel_slow2
    s_mov_b32 s53, 1
    s_nop 7
    s_nop 7
    s_branch sequential_preLN__grouped_kv_mqa__dense_activation_squared_relu__prompt_kernel_fin
sequential_preLN__grouped_kv_mqa__dense_activation_squared_relu__prompt_kernel_sc_13:
    v_mul_f32 v100, v100, v14
    v_mul_f32 v101, v101, v14
    v_mul_f32 v102, v102, v14
    v_mul_f32 v103, v103, v14
    v_cvt_pk_bf16_f32 v100, v100, v101
    v_cvt_pk_bf16_f32 v101, v102, v103
    buffer_store_dwordx2 v[100:101], v3, s[44:47], 0 offen offset:0 sc1
    v_mul_f32 v104, v104, v14
    v_mul_f32 v105, v105, v14
    v_mul_f32 v106, v106, v14
    v_mul_f32 v107, v107, v14
    v_cvt_pk_bf16_f32 v104, v104, v105
    v_cvt_pk_bf16_f32 v105, v106, v107
    buffer_store_dwordx2 v[104:105], v3, s[44:47], 0 offen offset:256 sc1
    v_mul_f32 v108, v108, v14
    v_mul_f32 v109, v109, v14
    v_mul_f32 v110, v110, v14
    v_mul_f32 v111, v111, v14
    v_cvt_pk_bf16_f32 v108, v108, v109
    v_cvt_pk_bf16_f32 v109, v110, v111
    s_mov_b32 exec_lo, 0xffffffff
    s_mov_b32 exec_hi, 0x0
    buffer_store_dwordx2 v[108:109], v3, s[44:47], 0 offen offset:512 sc1
    s_mov_b64 exec, -1
    v_lshlrev_b32 v13, 8, v1
    v_mov_b32 v14, s94
    v_mov_b32 v15, s95
    s_waitcnt vmcnt(0)
    s_mov_b32 exec_lo, 0xffff
    s_mov_b32 exec_hi, 0x0
    buffer_store_dwordx2 v[14:15], v13, s[64:67], s40 offen sc1
    s_mov_b64 exec, -1
    s_branch sequential_preLN__grouped_kv_mqa__dense_activation_squared_relu__prompt_kernel_sc_14
sequential_preLN__grouped_kv_mqa__dense_activation_squared_relu__prompt_kernel_sc_16:
    buffer_store_dwordx2 v[248:249], v12, s[40:43], 0 offen offset:0 sc1
    buffer_store_dwordx2 v[250:251], v12, s[40:43], 0 offen offset:512 sc1
    buffer_store_dwordx2 v[252:253], v12, s[40:43], 0 offen offset:1024 sc1
    buffer_store_dwordx2 v[254:255], v12, s[40:43], 0 offen offset:1536 sc1
    buffer_store_dwordx2 v[2:3], v12, s[40:43], 0 offen offset:2048 sc1
    s_branch sequential_preLN__grouped_kv_mqa__dense_activation_squared_relu__prompt_kernel_sc_17
sequential_preLN__grouped_kv_mqa__dense_activation_squared_relu__prompt_kernel_sc_18:
    buffer_store_dwordx2 v[14:15], v13, s[48:51], 0 offen sc1
    v_lshlrev_b32 v16, 8, v1
    v_mov_b32 v18, s94
    v_mov_b32 v19, s95
    s_waitcnt vmcnt(0)
    s_mov_b32 exec_lo, 0xffff
    s_mov_b32 exec_hi, 0x0
    buffer_store_dwordx2 v[18:19], v16, s[64:67], s63 offen sc1
    s_mov_b64 exec, -1
    s_branch sequential_preLN__grouped_kv_mqa__dense_activation_squared_relu__prompt_kernel_sc_19
sequential_preLN__grouped_kv_mqa__dense_activation_squared_relu__prompt_kernel_sc_21:
    v_max_f32 v200, 0, v200
    v_max_f32 v201, 0, v201
    v_max_f32 v202, 0, v202
    v_max_f32 v203, 0, v203
    v_pk_mul_f32 v[16:17], v[200:201], v[192:193]
    v_pk_mul_f32 v[18:19], v[202:203], v[192:193]
    v_pk_mul_f32 v[200:201], v[200:201], v[16:17]
    v_pk_mul_f32 v[202:203], v[202:203], v[18:19]
    v_cvt_pk_bf16_f32 v200, v200, v201
    v_cvt_pk_bf16_f32 v201, v202, v203
    buffer_store_dwordx2 v[200:201], v12, s[56:59], 0 offen offset:0 sc1
    v_max_f32 v224, 0, v224
    v_max_f32 v225, 0, v225
    v_max_f32 v226, 0, v226
    v_max_f32 v227, 0, v227
    v_pk_mul_f32 v[16:17], v[224:225], v[196:197]
    v_pk_mul_f32 v[18:19], v[226:227], v[196:197]
    v_pk_mul_f32 v[224:225], v[224:225], v[16:17]
    v_pk_mul_f32 v[226:227], v[226:227], v[18:19]
    v_cvt_pk_bf16_f32 v224, v224, v225
    v_cvt_pk_bf16_f32 v225, v226, v227
    buffer_store_dwordx2 v[224:225], v12, s[56:59], s6 offen offset:0 sc1
    v_max_f32 v204, 0, v204
    v_max_f32 v205, 0, v205
    v_max_f32 v206, 0, v206
    v_max_f32 v207, 0, v207
    v_pk_mul_f32 v[16:17], v[204:205], v[192:193]
    v_pk_mul_f32 v[18:19], v[206:207], v[192:193]
    v_pk_mul_f32 v[204:205], v[204:205], v[16:17]
    v_pk_mul_f32 v[206:207], v[206:207], v[18:19]
    v_cvt_pk_bf16_f32 v204, v204, v205
    v_cvt_pk_bf16_f32 v205, v206, v207
    buffer_store_dwordx2 v[204:205], v12, s[56:59], 0 offen offset:512 sc1
    v_max_f32 v228, 0, v228
    v_max_f32 v229, 0, v229
    v_max_f32 v230, 0, v230
    v_max_f32 v231, 0, v231
    v_pk_mul_f32 v[16:17], v[228:229], v[196:197]
    v_pk_mul_f32 v[18:19], v[230:231], v[196:197]
    v_pk_mul_f32 v[228:229], v[228:229], v[16:17]
    v_pk_mul_f32 v[230:231], v[230:231], v[18:19]
    v_cvt_pk_bf16_f32 v228, v228, v229
    v_cvt_pk_bf16_f32 v229, v230, v231
    buffer_store_dwordx2 v[228:229], v12, s[56:59], s6 offen offset:512 sc1
    v_max_f32 v208, 0, v208
    v_max_f32 v209, 0, v209
    v_max_f32 v210, 0, v210
    v_max_f32 v211, 0, v211
    v_pk_mul_f32 v[16:17], v[208:209], v[192:193]
    v_pk_mul_f32 v[18:19], v[210:211], v[192:193]
    v_pk_mul_f32 v[208:209], v[208:209], v[16:17]
    v_pk_mul_f32 v[210:211], v[210:211], v[18:19]
    v_cvt_pk_bf16_f32 v208, v208, v209
    v_cvt_pk_bf16_f32 v209, v210, v211
    buffer_store_dwordx2 v[208:209], v12, s[56:59], 0 offen offset:1024 sc1
    v_max_f32 v232, 0, v232
    v_max_f32 v233, 0, v233
    v_max_f32 v234, 0, v234
    v_max_f32 v235, 0, v235
    v_pk_mul_f32 v[16:17], v[232:233], v[196:197]
    v_pk_mul_f32 v[18:19], v[234:235], v[196:197]
    v_pk_mul_f32 v[232:233], v[232:233], v[16:17]
    v_pk_mul_f32 v[234:235], v[234:235], v[18:19]
    v_cvt_pk_bf16_f32 v232, v232, v233
    v_cvt_pk_bf16_f32 v233, v234, v235
    buffer_store_dwordx2 v[232:233], v12, s[56:59], s6 offen offset:1024 sc1
    v_max_f32 v212, 0, v212
    v_max_f32 v213, 0, v213
    v_max_f32 v214, 0, v214
    v_max_f32 v215, 0, v215
    v_pk_mul_f32 v[16:17], v[212:213], v[192:193]
    v_pk_mul_f32 v[18:19], v[214:215], v[192:193]
    v_pk_mul_f32 v[212:213], v[212:213], v[16:17]
    v_pk_mul_f32 v[214:215], v[214:215], v[18:19]
    v_cvt_pk_bf16_f32 v212, v212, v213
    v_cvt_pk_bf16_f32 v213, v214, v215
    buffer_store_dwordx2 v[212:213], v12, s[56:59], 0 offen offset:1536 sc1
    v_max_f32 v236, 0, v236
    v_max_f32 v237, 0, v237
    v_max_f32 v238, 0, v238
    v_max_f32 v239, 0, v239
    v_pk_mul_f32 v[16:17], v[236:237], v[196:197]
    v_pk_mul_f32 v[18:19], v[238:239], v[196:197]
    v_pk_mul_f32 v[236:237], v[236:237], v[16:17]
    v_pk_mul_f32 v[238:239], v[238:239], v[18:19]
    v_cvt_pk_bf16_f32 v236, v236, v237
    v_cvt_pk_bf16_f32 v237, v238, v239
    buffer_store_dwordx2 v[236:237], v12, s[56:59], s6 offen offset:1536 sc1
    v_max_f32 v216, 0, v216
    v_max_f32 v217, 0, v217
    v_max_f32 v218, 0, v218
    v_max_f32 v219, 0, v219
    v_pk_mul_f32 v[16:17], v[216:217], v[192:193]
    v_pk_mul_f32 v[18:19], v[218:219], v[192:193]
    v_pk_mul_f32 v[216:217], v[216:217], v[16:17]
    v_pk_mul_f32 v[218:219], v[218:219], v[18:19]
    v_cvt_pk_bf16_f32 v216, v216, v217
    v_cvt_pk_bf16_f32 v217, v218, v219
    buffer_store_dwordx2 v[216:217], v12, s[56:59], 0 offen offset:2048 sc1
    v_max_f32 v240, 0, v240
    v_max_f32 v241, 0, v241
    v_max_f32 v242, 0, v242
    v_max_f32 v243, 0, v243
    v_pk_mul_f32 v[16:17], v[240:241], v[196:197]
    v_pk_mul_f32 v[18:19], v[242:243], v[196:197]
    v_pk_mul_f32 v[240:241], v[240:241], v[16:17]
    v_pk_mul_f32 v[242:243], v[242:243], v[18:19]
    v_cvt_pk_bf16_f32 v240, v240, v241
    v_cvt_pk_bf16_f32 v241, v242, v243
    buffer_store_dwordx2 v[240:241], v12, s[56:59], s6 offen offset:2048 sc1
    v_max_f32 v220, 0, v220
    v_max_f32 v221, 0, v221
    v_max_f32 v222, 0, v222
    v_max_f32 v223, 0, v223
    v_pk_mul_f32 v[16:17], v[220:221], v[192:193]
    v_pk_mul_f32 v[18:19], v[222:223], v[192:193]
    v_pk_mul_f32 v[220:221], v[220:221], v[16:17]
    v_pk_mul_f32 v[222:223], v[222:223], v[18:19]
    v_cvt_pk_bf16_f32 v220, v220, v221
    v_cvt_pk_bf16_f32 v221, v222, v223
    buffer_store_dwordx2 v[220:221], v12, s[56:59], 0 offen offset:2560 sc1
    v_max_f32 v244, 0, v244
    v_max_f32 v245, 0, v245
    v_max_f32 v246, 0, v246
    v_max_f32 v247, 0, v247
    v_pk_mul_f32 v[16:17], v[244:245], v[196:197]
    v_pk_mul_f32 v[18:19], v[246:247], v[196:197]
    v_pk_mul_f32 v[244:245], v[244:245], v[16:17]
    v_pk_mul_f32 v[246:247], v[246:247], v[18:19]
    v_cvt_pk_bf16_f32 v244, v244, v245
    v_cvt_pk_bf16_f32 v245, v246, v247
    buffer_store_dwordx2 v[244:245], v12, s[56:59], s6 offen offset:2560 sc1
    v_lshlrev_b32 v16, 8, v1
    v_mov_b32 v18, s94
    v_mov_b32 v19, s95
    s_waitcnt vmcnt(0)
    s_mov_b32 exec_lo, 0xffff
    s_mov_b32 exec_hi, 0x0
    buffer_store_dwordx2 v[18:19], v16, s[64:67], s52 offen sc1
    s_mov_b64 exec, -1
    s_branch sequential_preLN__grouped_kv_mqa__dense_activation_squared_relu__prompt_kernel_sc_22
L_codeend:
.section .rodata,"a"
.p2align 6
.amdhsa_kernel sequential_preLN__grouped_kv_mqa__dense_activation_squared_relu__prompt_kernel
  .amdhsa_next_free_vgpr 256
  .amdhsa_next_free_sgpr 102
  .amdhsa_accum_offset 256
  .amdhsa_group_segment_fixed_size 0
  .amdhsa_kernarg_size 104
  .amdhsa_user_sgpr_count 2
  .amdhsa_user_sgpr_kernarg_segment_ptr 1
  .amdhsa_system_sgpr_workgroup_id_x 1
.end_amdhsa_kernel
```
